```python
import torch

def _softmax(x, axis=-1):
    return torch.softmax(x, dim=axis)
def _gelu(x):
    return torch.nn.functional.gelu(x, approximate="tanh")
def _silu(x):
    return torch.nn.functional.silu(x)
def _sigmoid(x):
    return torch.sigmoid(x)
def _layernorm(x, axis=-1, eps=1e-5):
    m = x.mean(dim=axis, keepdim=True)
    v = x.var(dim=axis, keepdim=True, unbiased=False)
    return (x - m) / torch.sqrt(v + eps)
def _scatter_add(tgt, idx, src, axis=0):
    return tgt.clone().index_add_(axis, idx, src)
def _segment_sum(src, seg, n):
    out = torch.zeros((n,) + src.shape[1:], dtype=src.dtype)
    return out.index_add_(0, seg, src)
def _pad(x, pw):
    flat = tuple(v for pair in reversed(pw) for v in pair)
    return torch.nn.functional.pad(x, flat)

kernel_name = 'standalone__self_sup_conv_stem_wavlm__speech'

def setup_inputs():

    _w = (lambda a: (lambda t: t.to(torch.bfloat16) if t.is_floating_point() else t)(torch.as_tensor(a)))
    B, T, D, K = 2, 4000, 256, 15
    scale = (K * D) ** -0.5
    return {
        "x": _w((lambda *s: torch.randn(*s, dtype=torch.bfloat16) * 0.05)(B, T, D)),
        "w": _w((lambda *s: torch.randn(*s, dtype=torch.bfloat16) * 0.05)(K, D, D) * scale),
        "gn_gamma": _w((lambda *s: torch.randn(*s, dtype=torch.bfloat16) * 0.05)(D) * 0.1 + 1.0),
        "gn_beta": _w((lambda *s: torch.randn(*s, dtype=torch.bfloat16) * 0.05)(D) * 0.1),
    }

def reference(x, w, gn_gamma, gn_beta):
    B, T, D = x.shape
    K = w.shape[0]
    s = 2
    L = (T - K) // s + 1
    h = torch.einsum('blc,cd->bld', x[:, 0:s * L:s, :], w[0])
    for i in range(1, K):
        h = h + torch.einsum('blc,cd->bld', x[:, i:i + s * L:s, :], w[i])
    mu = torch.einsum('bld->bd', h)[:, None, :] / L
    var = torch.einsum('bld->bd', (h - mu) ** 2)[:, None, :] / L
    h = (h - mu) / torch.sqrt(var + 1e-5)
    h = h * gn_gamma[None, None, :] + gn_beta[None, None, :]
    return _gelu(h)
```

```asm
; @launch grid=(256,1,1) block=(512,1,1) lds=163840
.amdgcn_target "amdgcn-amd-amdhsa--gfx950"
.text
.globl standalone__self_sup_conv_stem_wavlm__speech_kernel
.p2align 8
.type standalone__self_sup_conv_stem_wavlm__speech_kernel,@function
standalone__self_sup_conv_stem_wavlm__speech_kernel:
s_load_dwordx2 s[20:21], s[0:1], 0
s_load_dwordx2 s[24:25], s[0:1], 8
s_cmp_ge_u32 s2, 256
s_cbranch_scc1 L_exit
v_readfirstlane_b32 s35, v0
s_nop 0
v_and_b32 v0, 63, v0
s_lshr_b32 s35, s35, 6
s_cmp_lt_u32 s35, 4
s_cbranch_scc1 L_loader
s_mov_b64 exec, 0
s_cmp_eq_u32 s35, 5
s_cbranch_scc1 L_pad1
s_cmp_eq_u32 s35, 6
s_cbranch_scc1 L_pad2
s_cmp_eq_u32 s35, 7
s_cbranch_scc1 L_service
s_branch L_compute
L_exit:
s_endpgm
L_loader:
s_and_b32 s30, s2, 1
s_bfe_u32 s34, s2, 0x10001
s_bfe_u32 s31, s2, 0x10002
s_xor_b32 s31, s31, s34
s_bfe_u32 s32, s2, 0x40003
s_lshr_b32 s33, s2, 7
s_lshl_b32 s36, s31, 1
s_add_u32 s36, s36, s33
v_lshrrev_b32 v3, 3, v0
v_and_b32 v4, 7, v0
v_and_b32 v5, 3, v3
v_lshlrev_b32 v5, 10, v5
v_lshl_add_u32 v5, v4, 4, v5
v_lshrrev_b32 v6, 5, v0
v_lshl_add_u32 v8, v6, 16, v5
s_lshl_b32 s38, s35, 12
v_add_u32 v8, s38, v8
s_and_b32 s39, s35, 1
s_lshr_b32 s37, s35, 1
s_lshl_b32 s40, s39, 16
s_lshl_b32 s41, s37, 12
s_add_u32 s40, s40, s41
s_add_u32 s40, s40, 0x10000
v_add_u32 v9, s40, v5
s_lshl_b32 s40, s39, 2
v_and_b32 v7, 2, v3
v_xor_b32 v7, v7, v4
v_xor_b32 v7, s40, v7
v_lshlrev_b32 v7, 4, v7
v_lshl_add_u32 v7, v3, 9, v7
v_add_u32 v10, s38, v7
s_lshl_b32 s44, s30, 16
s_lshl_b32 s41, s36, 7
s_add_u32 s44, s44, s41
s_lshl_b32 s48, s32, 17
s_lshl_b32 s41, s30, 8
s_add_u32 s48, s48, s41
s_mul_i32 s41, s34, 2048000
s_add_u32 s48, s48, s41
s_add_u32 s22, s41, 2047488
s_mul_i32 s51, s35, 1056
s_mul_i32 s53, s37, 1056
s_lshl_b32 s41, s39, 9
s_add_u32 s53, s53, s41
s_lshl_b32 s54, s35, 10
s_lshl_b32 s41, s32, 1
s_add_u32 s41, s41, s39
s_lshl_b32 s40, s37, 5
s_add_u32 s41, s41, s40
s_lshl_b32 s41, s41, 9
v_lshl_add_u32 v17, v4, 18, s41
s_mov_b32 s23, 0x20000
s_mov_b32 s26, 1966080
s_mov_b32 s27, 0x20000
s_add_u32 m0, s54, 76032
s_add_u32 s40, s44, 0
s_waitcnt lgkmcnt(0)
buffer_load_dwordx4 v10, s[24:27], s40 offen lds
s_add_u32 m0, s51, 0
s_add_u32 s40, s48, 0
buffer_load_dwordx4 v8, s[20:23], s40 offen lds
s_add_u32 m0, s51, 4224
s_add_u32 s40, s48, 16384
buffer_load_dwordx4 v8, s[20:23], s40 offen lds
s_add_u32 m0, s51, 8448
s_add_u32 s40, s48, 32768
buffer_load_dwordx4 v8, s[20:23], s40 offen lds
s_add_u32 m0, s51, 12672
s_add_u32 s40, s48, 49152
buffer_load_dwordx4 v8, s[20:23], s40 offen lds
s_add_u32 m0, s53, 16896
s_add_u32 s40, s48, 0
s_mov_b32 exec_hi, 0
buffer_load_dwordx4 v9, s[20:23], s40 offen lds
s_mov_b32 exec_hi, -1
s_add_u32 s40, s44, 0
s_mov_b64 exec, 0xff
buffer_load_dword v19, v17, s[24:27], s40 offen
s_mov_b64 exec, -1
s_add_u32 m0, s54, 80128
s_add_u32 s40, s44, 262144
buffer_load_dwordx4 v10, s[24:27], s40 offen lds
s_add_u32 m0, s54, 84224
s_add_u32 s40, s44, 524288
buffer_load_dwordx4 v10, s[24:27], s40 offen lds
s_bfe_u32 s50, s2, 0x10002
s_lshl_b32 s41, s50, 15
s_add_u32 s52, s44, s41
s_xor_b32 s66, s52, 0x8000
s_lshl_b32 s41, s50, 7
s_add_u32 s50, s48, s41
s_xor_b32 s3, s50, 128
s_load_dwordx8 s[8:15], s[0:1], 16
s_load_dwordx2 s[16:17], s[0:1], 48
v_and_b32 v1, 15, v0
v_lshrrev_b32 v2, 4, v0
s_mov_b32 s62, 2359296
s_mov_b32 s63, 0x20000
s_lshl_b32 s42, s34, 2
s_add_u32 s42, s42, s36
s_lshl_b32 s33, s42, 2
s_mul_i32 s47, s42, 4352
s_add_u32 s47, s47, 131072
s_lshl_b32 s42, s42, 1
s_add_u32 s42, s42, s30
s_and_b32 s38, s35, 1
s_bfe_u32 s39, s35, 0x10001
s_lshl_b32 s43, s42, 13
s_lshl_b32 s41, s38, 12
s_add_u32 s43, s43, s41
s_lshl_b32 s49, s32, 1
s_add_u32 s49, s49, s39
s_lshl_b32 s46, s49, 7
s_add_u32 s46, s46, s43
s_lshl_b32 s65, s2, 13
s_and_b32 s41, s35, 3
s_lshl_b32 s41, s41, 11
s_add_u32 s65, s65, s41
s_add_u32 s65, s65, 262144
v_lshlrev_b32 v24, 4, v0
v_lshrrev_b32 v25, 1, v2
v_lshlrev_b32 v25, 2, v25
v_lshl_add_u32 v25, v1, 3, v25
v_mov_b32 v4, -1
v_mov_b32 v5, -1
v_mov_b32 v6, -1
v_mov_b32 v7, -1
s_lshl_b32 s55, s36, 7
s_lshl_b32 s41, s30, 6
s_add_u32 s55, s55, s41
s_waitcnt lgkmcnt(0)
s_lshl_b32 s41, s38, 5
s_add_u32 s41, s55, s41
v_and_b32 v16, 7, v0
v_lshrrev_b32 v23, 5, v0
v_lshl_add_u32 v16, v16, 1, v23
v_lshl_add_u32 v23, v16, 1, s41
s_or_b32 s31, s32, s30
s_xor_b32 s41, s35, 3
s_or_b32 s31, s31, s41
s_cbranch_scc1 L_noroot
s_mov_b64 s[4:5], 0
s_atomic_swap_x2 s[4:5], s[16:17], s47 glc
L_noroot:
s_add_u32 m0, s54, 88320
s_add_u32 s40, s44, 786432
buffer_load_dwordx4 v10, s[24:27], s40 offen lds
s_add_u32 m0, s54, 92416
s_add_u32 s40, s44, 1048576
buffer_load_dwordx4 v10, s[24:27], s40 offen lds
s_add_u32 m0, s54, 96512
s_add_u32 s40, s44, 1310720
buffer_load_dwordx4 v10, s[24:27], s40 offen lds
s_add_u32 m0, s54, 100608
s_add_u32 s40, s44, 1572864
buffer_load_dwordx4 v10, s[24:27], s40 offen lds
s_add_u32 m0, s54, 104704
s_add_u32 s40, s44, 1835008
buffer_load_dwordx4 v10, s[24:27], s40 offen lds
s_add_u32 m0, s54, 108800
s_add_u32 s40, s44, 16384
buffer_load_dwordx4 v10, s[24:27], s40 offen lds
s_waitcnt vmcnt(10)
s_barrier
s_cmp_lg_u32 s31, 0
s_cbranch_scc1 L_noroot2
s_waitcnt lgkmcnt(0)
s_mov_b32 s4, 1
s_atomic_add s4, s[14:15], s33
L_noroot2:
s_add_u32 m0, s54, 112896
s_add_u32 s40, s44, 278528
buffer_load_dwordx4 v10, s[24:27], s40 offen lds
s_add_u32 m0, s54, 116992
s_add_u32 s40, s44, 540672
buffer_load_dwordx4 v10, s[24:27], s40 offen lds
s_add_u32 m0, s54, 121088
s_add_u32 s40, s44, 802816
buffer_load_dwordx4 v10, s[24:27], s40 offen lds
s_waitcnt vmcnt(10)
s_barrier
s_add_u32 s40, s52, 131072
s_mov_b64 exec, 0xff
buffer_load_dword v19, v17, s[24:27], s40 offen
s_mov_b64 exec, -1
s_add_u32 m0, s51, 19008
s_add_u32 s40, s50, 512
buffer_load_dwordx4 v8, s[20:23], s40 offen lds
s_add_u32 m0, s51, 23232
s_add_u32 s40, s50, 16896
buffer_load_dwordx4 v8, s[20:23], s40 offen lds
s_waitcnt vmcnt(11)
s_barrier
s_add_u32 m0, s51, 27456
s_add_u32 s40, s50, 33280
buffer_load_dwordx4 v8, s[20:23], s40 offen lds
s_add_u32 m0, s51, 31680
s_add_u32 s40, s50, 49664
buffer_load_dwordx4 v8, s[20:23], s40 offen lds
s_add_u32 m0, s53, 35904
s_add_u32 s40, s50, 512
s_mov_b32 exec_hi, 0
buffer_load_dwordx4 v9, s[20:23], s40 offen lds
s_mov_b32 exec_hi, -1
s_waitcnt vmcnt(12)
s_barrier
s_add_u32 m0, s54, 125184
s_add_u32 s40, s44, 1064960
buffer_load_dwordx4 v10, s[24:27], s40 offen lds
s_add_u32 m0, s54, 129280
s_add_u32 s40, s44, 1327104
buffer_load_dwordx4 v10, s[24:27], s40 offen lds
s_add_u32 m0, s54, 133376
s_add_u32 s40, s44, 1589248
buffer_load_dwordx4 v10, s[24:27], s40 offen lds
s_add_u32 m0, s54, 137472
s_add_u32 s40, s44, 1851392
buffer_load_dwordx4 v10, s[24:27], s40 offen lds
s_add_u32 m0, s54, 141568
s_add_u32 s40, s52, 131072
buffer_load_dwordx4 v10, s[24:27], s40 offen lds
s_add_u32 m0, s54, 145664
s_add_u32 s40, s52, 393216
buffer_load_dwordx4 v10, s[24:27], s40 offen lds
s_waitcnt vmcnt(12)
s_barrier
s_add_u32 m0, s54, 149760
s_add_u32 s40, s52, 655360
buffer_load_dwordx4 v10, s[24:27], s40 offen lds
s_add_u32 m0, s54, 153856
s_add_u32 s40, s52, 917504
buffer_load_dwordx4 v10, s[24:27], s40 offen lds
s_add_u32 m0, s54, 157952
s_add_u32 s40, s52, 1179648
buffer_load_dwordx4 v10, s[24:27], s40 offen lds
s_add_u32 m0, s54, 76032
s_add_u32 s40, s52, 1441792
buffer_load_dwordx4 v10, s[24:27], s40 offen lds
s_add_u32 m0, s54, 80128
s_add_u32 s40, s52, 1703936
buffer_load_dwordx4 v10, s[24:27], s40 offen lds
s_add_u32 m0, s54, 84224
s_add_u32 s40, s52, 147456
buffer_load_dwordx4 v10, s[24:27], s40 offen lds
s_add_u32 m0, s54, 88320
s_add_u32 s40, s52, 409600
buffer_load_dwordx4 v10, s[24:27], s40 offen lds
s_add_u32 m0, s54, 92416
s_add_u32 s40, s52, 671744
buffer_load_dwordx4 v10, s[24:27], s40 offen lds
s_add_u32 m0, s54, 96512
s_add_u32 s40, s52, 933888
buffer_load_dwordx4 v10, s[24:27], s40 offen lds
s_waitcnt vmcnt(8)
s_barrier
s_add_u32 m0, s54, 100608
s_add_u32 s40, s52, 1196032
buffer_load_dwordx4 v10, s[24:27], s40 offen lds
s_add_u32 m0, s54, 104704
s_add_u32 s40, s52, 1458176
buffer_load_dwordx4 v10, s[24:27], s40 offen lds
s_add_u32 m0, s54, 108800
s_add_u32 s40, s52, 1720320
buffer_load_dwordx4 v10, s[24:27], s40 offen lds
s_add_u32 s40, s44, 32768
s_mov_b64 exec, 0xff
buffer_load_dword v19, v17, s[24:27], s40 offen
s_mov_b64 exec, -1
s_add_u32 m0, s51, 38016
s_add_u32 s40, s48, 128
buffer_load_dwordx4 v8, s[20:23], s40 offen lds
s_add_u32 m0, s51, 42240
s_add_u32 s40, s48, 16512
buffer_load_dwordx4 v8, s[20:23], s40 offen lds
s_add_u32 m0, s51, 46464
s_add_u32 s40, s48, 32896
buffer_load_dwordx4 v8, s[20:23], s40 offen lds
s_add_u32 m0, s51, 50688
s_add_u32 s40, s48, 49280
buffer_load_dwordx4 v8, s[20:23], s40 offen lds
s_add_u32 m0, s53, 54912
s_add_u32 s40, s48, 128
s_mov_b32 exec_hi, 0
buffer_load_dwordx4 v9, s[20:23], s40 offen lds
s_mov_b32 exec_hi, -1
s_waitcnt vmcnt(12)
s_barrier
global_load_ushort v20, v23, s[8:9]
global_load_ushort v21, v23, s[10:11]
s_add_u32 m0, s54, 112896
s_add_u32 s40, s44, 32768
buffer_load_dwordx4 v10, s[24:27], s40 offen lds
s_add_u32 m0, s54, 116992
s_add_u32 s40, s44, 294912
buffer_load_dwordx4 v10, s[24:27], s40 offen lds
s_add_u32 m0, s54, 121088
s_add_u32 s40, s44, 557056
buffer_load_dwordx4 v10, s[24:27], s40 offen lds
s_mov_b64 s[60:61], s[16:17]
buffer_store_dwordx4 v[4:7], v24, s[60:63], s65 offen offset:0 sc1
s_waitcnt vmcnt(12)
s_barrier
s_add_u32 m0, s54, 125184
s_add_u32 s40, s44, 819200
buffer_load_dwordx4 v10, s[24:27], s40 offen lds
s_add_u32 m0, s54, 129280
s_add_u32 s40, s44, 1081344
buffer_load_dwordx4 v10, s[24:27], s40 offen lds
s_add_u32 m0, s54, 133376
s_add_u32 s40, s44, 1343488
buffer_load_dwordx4 v10, s[24:27], s40 offen lds
buffer_store_dwordx4 v[4:7], v24, s[60:63], s65 offen offset:1024 sc1
buffer_store_dword v4, v25, s[60:63], s46 offen sc1
s_add_u32 m0, s54, 137472
s_add_u32 s40, s44, 1605632
buffer_load_dwordx4 v10, s[24:27], s40 offen lds
s_add_u32 m0, s54, 141568
s_add_u32 s40, s44, 1867776
buffer_load_dwordx4 v10, s[24:27], s40 offen lds
s_add_u32 m0, s54, 145664
s_add_u32 s40, s44, 49152
buffer_load_dwordx4 v10, s[24:27], s40 offen lds
s_add_u32 m0, s54, 149760
s_add_u32 s40, s44, 311296
buffer_load_dwordx4 v10, s[24:27], s40 offen lds
s_add_u32 m0, s54, 153856
s_add_u32 s40, s44, 573440
buffer_load_dwordx4 v10, s[24:27], s40 offen lds
s_waitcnt vmcnt(12)
s_barrier
s_add_u32 m0, s54, 157952
s_add_u32 s40, s44, 835584
buffer_load_dwordx4 v10, s[24:27], s40 offen lds
s_add_u32 m0, s54, 76032
s_add_u32 s40, s44, 1097728
buffer_load_dwordx4 v10, s[24:27], s40 offen lds
s_add_u32 m0, s54, 80128
s_add_u32 s40, s44, 1359872
buffer_load_dwordx4 v10, s[24:27], s40 offen lds
s_add_u32 m0, s54, 84224
s_add_u32 s40, s44, 1622016
buffer_load_dwordx4 v10, s[24:27], s40 offen lds
s_add_u32 m0, s54, 88320
s_add_u32 s40, s44, 1884160
buffer_load_dwordx4 v10, s[24:27], s40 offen lds
s_waitcnt vmcnt(12)
s_barrier
s_load_dword s6, s[14:15], s33
s_add_u32 m0, s51, 57024
s_add_u32 s40, s3, 512
buffer_load_dwordx4 v8, s[20:23], s40 offen lds
s_add_u32 m0, s51, 61248
s_add_u32 s40, s3, 16896
buffer_load_dwordx4 v8, s[20:23], s40 offen lds
s_add_u32 m0, s51, 65472
s_add_u32 s40, s3, 33280
buffer_load_dwordx4 v8, s[20:23], s40 offen lds
s_add_u32 m0, s51, 69696
s_add_u32 s40, s3, 49664
buffer_load_dwordx4 v8, s[20:23], s40 offen lds
s_add_u32 m0, s53, 73920
s_add_u32 s40, s3, 512
s_mov_b32 exec_hi, 0
buffer_load_dwordx4 v9, s[20:23], s40 offen lds
s_mov_b32 exec_hi, -1
s_add_u32 m0, s54, 92416
s_add_u32 s40, s66, 131072
buffer_load_dwordx4 v10, s[24:27], s40 offen lds
s_add_u32 m0, s54, 96512
s_add_u32 s40, s66, 393216
buffer_load_dwordx4 v10, s[24:27], s40 offen lds
s_waitcnt vmcnt(12)
s_barrier
s_cmp_lg_u32 s35, 3
s_cbranch_scc1 L_noflag
s_mov_b32 s7, 0x40000
s_waitcnt lgkmcnt(0)
L_root:
s_cmp_lg_u32 s6, 0
s_cbranch_scc1 L_rootok
s_atomic_add s6, s[14:15], s33 glc
s_sub_u32 s7, s7, 1
s_waitcnt lgkmcnt(0)
s_cbranch_scc0 L_root
L_rootok:
s_getreg_b32 s40, hwreg(HW_REG_XCC_ID, 0, 4)
s_mul_i32 s41, s40, s40
s_lshl_b32 s41, s41, 13
s_lshl_b32 s40, s40, 5
s_add_u32 s40, s40, s41
s_add_u32 s40, s40, 1
s_cmp_eq_u32 s30, 0
s_cselect_b32 s18, s40, 0
s_cselect_b32 s19, 0, s40
s_atomic_add_x2 s[18:19], s[16:17], s47
L_noflag:
s_add_u32 m0, s54, 100608
s_add_u32 s40, s66, 655360
buffer_load_dwordx4 v10, s[24:27], s40 offen lds
s_add_u32 m0, s54, 104704
s_add_u32 s40, s66, 917504
buffer_load_dwordx4 v10, s[24:27], s40 offen lds
s_add_u32 m0, s54, 108800
s_add_u32 s40, s66, 1179648
buffer_load_dwordx4 v10, s[24:27], s40 offen lds
s_add_u32 m0, s54, 0
s_add_u32 s40, s66, 1441792
buffer_load_dwordx4 v10, s[24:27], s40 offen lds
s_add_u32 m0, s54, 4096
s_add_u32 s40, s66, 1703936
buffer_load_dwordx4 v10, s[24:27], s40 offen lds
s_add_u32 m0, s54, 8192
s_add_u32 s40, s66, 147456
buffer_load_dwordx4 v10, s[24:27], s40 offen lds
s_waitcnt vmcnt(13)
s_barrier
s_add_u32 m0, s54, 12288
s_add_u32 s40, s66, 409600
buffer_load_dwordx4 v10, s[24:27], s40 offen lds
s_add_u32 m0, s54, 16384
s_add_u32 s40, s66, 671744
buffer_load_dwordx4 v10, s[24:27], s40 offen lds
s_add_u32 m0, s54, 20480
s_add_u32 s40, s66, 933888
buffer_load_dwordx4 v10, s[24:27], s40 offen lds
s_add_u32 m0, s54, 24576
s_add_u32 s40, s66, 1196032
buffer_load_dwordx4 v10, s[24:27], s40 offen lds
s_add_u32 m0, s54, 28672
s_add_u32 s40, s66, 1458176
buffer_load_dwordx4 v10, s[24:27], s40 offen lds
s_add_u32 m0, s54, 32768
s_add_u32 s40, s66, 1720320
buffer_load_dwordx4 v10, s[24:27], s40 offen lds
s_waitcnt vmcnt(10)
s_barrier
s_waitcnt vmcnt(5)
s_barrier
s_waitcnt vmcnt(3)
s_barrier
s_waitcnt vmcnt(0)
s_barrier
s_waitcnt lgkmcnt(0)
s_load_dwordx2 s[4:5], s[16:17], s47
s_branch L_service
.p2align 12
L_compute:
s_mov_b64 exec, -1
s_load_dwordx2 s[56:57], s[0:1], 32
s_load_dwordx2 s[60:61], s[0:1], 48
s_and_b32 s30, s2, 1
s_bfe_u32 s34, s2, 0x10001
s_bfe_u32 s31, s2, 0x10002
s_xor_b32 s31, s31, s34
s_bfe_u32 s32, s2, 0x40003
s_lshr_b32 s33, s2, 7
s_lshl_b32 s36, s31, 1
s_add_u32 s36, s36, s33
v_and_b32 v1, 15, v0
v_lshrrev_b32 v2, 4, v0
s_mul_i32 s53, s34, 1020416
s_add_u32 s58, s53, 1020416
s_mov_b32 s59, 0x20000
s_mov_b32 s62, 2359296
s_mov_b32 s63, 0x20000
s_lshl_b32 s42, s34, 2
s_add_u32 s42, s42, s36
s_lshl_b32 s42, s42, 1
s_add_u32 s42, s42, s30
s_and_b32 s38, s35, 1
s_bfe_u32 s39, s35, 0x10001
s_lshl_b32 s43, s42, 13
s_lshl_b32 s41, s38, 12
s_add_u32 s43, s43, s41
s_lshl_b32 s49, s32, 1
s_add_u32 s49, s49, s39
s_lshl_b32 s46, s49, 7
s_add_u32 s46, s46, s43
s_lshl_b32 s65, s2, 13
s_and_b32 s41, s35, 3
s_lshl_b32 s41, s41, 11
s_add_u32 s65, s65, s41
s_add_u32 s65, s65, 262144
s_xor_b32 s45, s65, 0x2000
v_lshlrev_b32 v24, 4, v0
v_lshrrev_b32 v25, 1, v2
v_lshlrev_b32 v25, 2, v25
v_lshl_add_u32 v25, v1, 3, v25
v_lshrrev_b32 v14, 3, v0
v_and_b32 v15, 7, v0
v_mul_u32_u24 v11, 144, v14
v_lshl_add_u32 v11, v15, 4, v11
s_mul_i32 s41, s35, 2304
s_add_u32 s41, s41, 112896
v_add_u32 v11, s41, v11
v_lshlrev_b32 v12, 4, v15
v_add_u32 v12, 131328, v12
v_lshlrev_b32 v13, 9, v14
s_lshl_b32 s55, s36, 7
s_lshl_b32 s41, s30, 6
s_add_u32 s55, s55, s41
s_lshl_b32 s64, s32, 16
s_lshl_b32 s41, s35, 13
s_add_u32 s64, s64, s41
s_add_u32 s64, s64, s53
s_add_u32 s64, s64, s55
s_add_u32 s53, s64, 0x1000
s_mov_b32 s28, 0x409d30fc
s_mov_b32 s29, 0xbf8bf336
v_mul_u32_u24 v3, 1056, v1
v_lshl_add_u32 v3, v2, 4, v3
s_lshl_b32 s40, s39, 9
v_add_u32 v16, s40, v3
s_lshl_b32 s40, s30, 1
s_add_u32 s40, s40, s38
v_bfe_u32 v3, v0, 3, 2
v_xor_b32 v3, s40, v3
v_lshlrev_b32 v3, 5, v3
v_lshrrev_b32 v4, 2, v1
v_lshl_add_u32 v4, v2, 3, v4
v_lshl_add_u32 v3, v4, 7, v3
v_and_b32 v4, 3, v0
v_lshl_add_u32 v18, v4, 3, v3
v_xor_b32 v21, 64, v18
v_add_u32 v19, 76032, v18
v_add_u32 v22, 76032, v21
v_add_u32 v20, 141568, v18
v_add_u32 v23, 141568, v21
v_mul_u32_u24 v26, 2304, v2
v_lshl_add_u32 v26, v1, 2, v26
s_mul_i32 s41, s39, 9216
s_lshl_b32 s40, s38, 6
s_add_u32 s41, s41, s40
s_add_u32 s41, s41, 112896
v_add_u32 v26, s41, v26
v_add_u32 v17, 1152, v26
v_mov_b32 v27, 162048
v_lshrrev_b32 v3, 2, v1
v_and_b32 v4, 1, v0
v_lshlrev_b32 v4, 4, v4
v_mov_b32 v5, 0x3f80
v_lshlrev_b32 v4, v4, v5
v_cmp_eq_u32 vcc, v3, v2
v_and_b32 v3, 2, v0
v_mov_b32 v80, 0
v_cndmask_b32 v4, 0, v4, vcc
v_cmp_eq_u32 vcc, 0, v3
v_mov_b32 v81, 0
v_mov_b32 v84, 0
v_cndmask_b32 v82, 0, v4, vcc
v_mov_b32 v85, 0
v_xor_b32 v83, v82, v4
s_mov_b32 s18, 1.0
s_cmp_eq_u32 s49, 31
s_cselect_b32 s19, 0, 1.0
s_waitcnt lgkmcnt(0)
s_barrier
ds_read_b64_tr_b16 v[88:89], v22 offset:0
ds_read_b64_tr_b16 v[90:91], v22 offset:512
ds_read_b128 v[92:95], v16 offset:0
ds_read_b128 v[96:99], v16 offset:128
ds_read_b128 v[100:103], v16 offset:256
ds_read_b128 v[104:107], v16 offset:384
s_waitcnt lgkmcnt(3)
v_mfma_f32_16x16x32_bf16 v[48:51], v[92:95], v[88:91], 0
ds_read_b64_tr_b16 v[108:109], v19 offset:0
ds_read_b64_tr_b16 v[110:111], v19 offset:512
s_waitcnt lgkmcnt(4)
v_mfma_f32_16x16x32_bf16 v[52:55], v[96:99], v[88:91], 0
s_barrier
ds_read_b64_tr_b16 v[112:113], v22 offset:4096
s_waitcnt lgkmcnt(4)
v_mfma_f32_16x16x32_bf16 v[56:59], v[100:103], v[88:91], 0
ds_read_b64_tr_b16 v[114:115], v22 offset:4608
s_waitcnt lgkmcnt(4)
v_mfma_f32_16x16x32_bf16 v[60:63], v[104:107], v[88:91], 0
ds_read_b128 v[116:119], v16 offset:1056
s_waitcnt lgkmcnt(3)
v_mfma_f32_16x16x32_bf16 v[44:47], v[104:107], v[108:111], 0
ds_read_b64_tr_b16 v[120:121], v19 offset:4096
v_mfma_f32_16x16x32_bf16 v[40:43], v[100:103], v[108:111], 0
ds_read_b64_tr_b16 v[122:123], v19 offset:4608
v_mfma_f32_16x16x32_bf16 v[36:39], v[96:99], v[108:111], 0
s_barrier
ds_read_b64_tr_b16 v[124:125], v22 offset:8192
v_mfma_f32_16x16x32_bf16 v[32:35], v[92:95], v[108:111], 0
ds_read_b64_tr_b16 v[126:127], v22 offset:8704
s_waitcnt lgkmcnt(4)
v_mfma_f32_16x16x32_bf16 v[48:51], v[96:99], v[112:115], v[48:51]
ds_read_b64_tr_b16 v[128:129], v22 offset:12288
v_mfma_f32_16x16x32_bf16 v[52:55], v[100:103], v[112:115], v[52:55]
ds_read_b64_tr_b16 v[130:131], v22 offset:12800
v_mfma_f32_16x16x32_bf16 v[56:59], v[104:107], v[112:115], v[56:59]
ds_read_b64_tr_b16 v[132:133], v19 offset:12288
v_mfma_f32_16x16x32_bf16 v[60:63], v[116:119], v[112:115], v[60:63]
ds_read_b64_tr_b16 v[134:135], v19 offset:12800
s_waitcnt lgkmcnt(4)
v_mfma_f32_16x16x32_bf16 v[44:47], v[116:119], v[120:123], v[44:47]
ds_read_b64_tr_b16 v[136:137], v19 offset:8192
v_mfma_f32_16x16x32_bf16 v[40:43], v[104:107], v[120:123], v[40:43]
ds_read_b64_tr_b16 v[138:139], v19 offset:8704
v_mfma_f32_16x16x32_bf16 v[36:39], v[100:103], v[120:123], v[36:39]
v_mfma_f32_16x16x32_bf16 v[32:35], v[96:99], v[120:123], v[32:35]
v_mfma_f32_16x16x32_bf16 v[48:51], v[100:103], v[124:127], v[48:51]
s_waitcnt lgkmcnt(1)
v_mfma_f32_16x16x32_bf16 v[48:51], v[104:107], v[128:131], v[48:51]
ds_read_b128 v[140:143], v16 offset:1184
v_mfma_f32_16x16x32_bf16 v[32:35], v[104:107], v[132:135], v[32:35]
s_waitcnt lgkmcnt(1)
v_mfma_f32_16x16x32_bf16 v[32:35], v[100:103], v[136:139], v[32:35]
ds_read_b128 v[144:147], v16 offset:1312
v_mfma_f32_16x16x32_bf16 v[36:39], v[104:107], v[136:139], v[36:39]
s_barrier
ds_read_b64_tr_b16 v[148:149], v22 offset:16384
v_mfma_f32_16x16x32_bf16 v[36:39], v[116:119], v[132:135], v[36:39]
ds_read_b64_tr_b16 v[150:151], v22 offset:16896
v_mfma_f32_16x16x32_bf16 v[52:55], v[116:119], v[128:131], v[52:55]
ds_read_b64_tr_b16 v[152:153], v22 offset:20480
v_mfma_f32_16x16x32_bf16 v[52:55], v[104:107], v[124:127], v[52:55]
ds_read_b64_tr_b16 v[154:155], v22 offset:20992
v_mfma_f32_16x16x32_bf16 v[56:59], v[116:119], v[124:127], v[56:59]
ds_read_b64_tr_b16 v[156:157], v19 offset:20480
s_waitcnt lgkmcnt(4)
v_mfma_f32_16x16x32_bf16 v[56:59], v[140:143], v[128:131], v[56:59]
ds_read_b64_tr_b16 v[158:159], v19 offset:20992
v_mfma_f32_16x16x32_bf16 v[40:43], v[140:143], v[132:135], v[40:43]
ds_read_b64_tr_b16 v[160:161], v19 offset:16384
v_mfma_f32_16x16x32_bf16 v[40:43], v[116:119], v[136:139], v[40:43]
ds_read_b64_tr_b16 v[162:163], v19 offset:16896
v_mfma_f32_16x16x32_bf16 v[44:47], v[140:143], v[136:139], v[44:47]
v_mfma_f32_16x16x32_bf16 v[44:47], v[144:147], v[132:135], v[44:47]
v_mfma_f32_16x16x32_bf16 v[60:63], v[144:147], v[128:131], v[60:63]
v_mfma_f32_16x16x32_bf16 v[60:63], v[140:143], v[124:127], v[60:63]
s_waitcnt lgkmcnt(0)
v_mfma_f32_16x16x32_bf16 v[48:51], v[116:119], v[148:151], v[48:51]
v_mfma_f32_16x16x32_bf16 v[48:51], v[140:143], v[152:155], v[48:51]
ds_read_b128 v[164:167], v16 offset:1440
v_mfma_f32_16x16x32_bf16 v[32:35], v[140:143], v[156:159], v[32:35]
v_mfma_f32_16x16x32_bf16 v[32:35], v[116:119], v[160:163], v[32:35]
ds_read_b128 v[168:171], v16 offset:2112
v_mfma_f32_16x16x32_bf16 v[36:39], v[140:143], v[160:163], v[36:39]
s_barrier
ds_read_b64_tr_b16 v[172:173], v22 offset:24576
v_mfma_f32_16x16x32_bf16 v[36:39], v[144:147], v[156:159], v[36:39]
ds_read_b64_tr_b16 v[174:175], v22 offset:25088
v_mfma_f32_16x16x32_bf16 v[52:55], v[144:147], v[152:155], v[52:55]
ds_read_b64_tr_b16 v[176:177], v22 offset:28672
v_mfma_f32_16x16x32_bf16 v[52:55], v[140:143], v[148:151], v[52:55]
ds_read_b64_tr_b16 v[178:179], v22 offset:29184
v_mfma_f32_16x16x32_bf16 v[56:59], v[144:147], v[148:151], v[56:59]
ds_read_b64_tr_b16 v[180:181], v19 offset:28672
s_waitcnt lgkmcnt(4)
v_mfma_f32_16x16x32_bf16 v[56:59], v[164:167], v[152:155], v[56:59]
ds_read_b64_tr_b16 v[182:183], v19 offset:29184
v_mfma_f32_16x16x32_bf16 v[40:43], v[164:167], v[156:159], v[40:43]
ds_read_b64_tr_b16 v[184:185], v19 offset:24576
v_mfma_f32_16x16x32_bf16 v[40:43], v[144:147], v[160:163], v[40:43]
ds_read_b64_tr_b16 v[186:187], v19 offset:25088
v_mfma_f32_16x16x32_bf16 v[44:47], v[164:167], v[160:163], v[44:47]
v_mfma_f32_16x16x32_bf16 v[44:47], v[168:171], v[156:159], v[44:47]
ds_read_b128 v[188:191], v16 offset:2240
v_mfma_f32_16x16x32_bf16 v[60:63], v[168:171], v[152:155], v[60:63]
ds_read_b128 v[192:195], v16 offset:2368
v_mfma_f32_16x16x32_bf16 v[60:63], v[164:167], v[148:151], v[60:63]
ds_read_b64_tr_b16 v[196:197], v22 offset:32768
s_waitcnt lgkmcnt(3)
v_mfma_f32_16x16x32_bf16 v[48:51], v[144:147], v[172:175], v[48:51]
ds_read_b64_tr_b16 v[198:199], v22 offset:33280
v_mfma_f32_16x16x32_bf16 v[48:51], v[164:167], v[176:179], v[48:51]
ds_read_b128 v[200:203], v16 offset:64
v_mfma_f32_16x16x32_bf16 v[32:35], v[164:167], v[180:183], v[32:35]
ds_read_b64_tr_b16 v[204:205], v22 offset:36864
ds_read_b64_tr_b16 v[206:207], v22 offset:37376
v_mfma_f32_16x16x32_bf16 v[32:35], v[144:147], v[184:187], v[32:35]
ds_read_b128 v[208:211], v16 offset:192
v_mfma_f32_16x16x32_bf16 v[36:39], v[164:167], v[184:187], v[36:39]
ds_read_b64_tr_b16 v[212:213], v22 offset:40960
v_mfma_f32_16x16x32_bf16 v[36:39], v[168:171], v[180:183], v[36:39]
ds_read_b64_tr_b16 v[214:215], v22 offset:41472
v_mfma_f32_16x16x32_bf16 v[52:55], v[168:171], v[176:179], v[52:55]
ds_read_b128 v[216:219], v16 offset:320
v_mfma_f32_16x16x32_bf16 v[52:55], v[164:167], v[172:175], v[52:55]
ds_read_b64_tr_b16 v[220:221], v22 offset:45056
v_mfma_f32_16x16x32_bf16 v[56:59], v[168:171], v[172:175], v[56:59]
ds_read_b64_tr_b16 v[222:223], v22 offset:45568
s_waitcnt lgkmcnt(4)
v_mfma_f32_16x16x32_bf16 v[56:59], v[188:191], v[176:179], v[56:59]
ds_read_b128 v[224:227], v16 offset:448
v_mfma_f32_16x16x32_bf16 v[40:43], v[188:191], v[180:183], v[40:43]
ds_read_b64_tr_b16 v[228:229], v19 offset:45056
v_mfma_f32_16x16x32_bf16 v[40:43], v[168:171], v[184:187], v[40:43]
ds_read_b64_tr_b16 v[230:231], v19 offset:45568
v_mfma_f32_16x16x32_bf16 v[44:47], v[188:191], v[184:187], v[44:47]
ds_read_b64_tr_b16 v[232:233], v19 offset:40960
v_mfma_f32_16x16x32_bf16 v[44:47], v[192:195], v[180:183], v[44:47]
ds_read_b64_tr_b16 v[234:235], v19 offset:41472
v_mfma_f32_16x16x32_bf16 v[60:63], v[192:195], v[176:179], v[60:63]
ds_read_b64_tr_b16 v[236:237], v19 offset:36864
v_mfma_f32_16x16x32_bf16 v[60:63], v[188:191], v[172:175], v[60:63]
ds_read_b64_tr_b16 v[238:239], v19 offset:37376
v_mfma_f32_16x16x32_bf16 v[48:51], v[200:203], v[196:199], v[48:51]
ds_read_b64_tr_b16 v[240:241], v19 offset:32768
v_mfma_f32_16x16x32_bf16 v[48:51], v[208:211], v[204:207], v[48:51]
ds_read_b64_tr_b16 v[242:243], v19 offset:33280
s_waitcnt lgkmcnt(4)
v_mfma_f32_16x16x32_bf16 v[48:51], v[216:219], v[212:215], v[48:51]
v_mfma_f32_16x16x32_bf16 v[48:51], v[224:227], v[220:223], v[48:51]
ds_read_b128 v[244:247], v16 offset:1120
v_mfma_f32_16x16x32_bf16 v[32:35], v[224:227], v[228:231], v[32:35]
v_mfma_f32_16x16x32_bf16 v[32:35], v[216:219], v[232:235], v[32:35]
s_waitcnt lgkmcnt(1)
v_mfma_f32_16x16x32_bf16 v[32:35], v[208:211], v[236:239], v[32:35]
v_mfma_f32_16x16x32_bf16 v[32:35], v[200:203], v[240:243], v[32:35]
v_mfma_f32_16x16x32_bf16 v[36:39], v[208:211], v[240:243], v[36:39]
v_mfma_f32_16x16x32_bf16 v[36:39], v[216:219], v[236:239], v[36:39]
v_mfma_f32_16x16x32_bf16 v[36:39], v[224:227], v[232:235], v[36:39]
s_waitcnt lgkmcnt(0)
v_mfma_f32_16x16x32_bf16 v[36:39], v[244:247], v[228:231], v[36:39]
ds_read_b128 v[248:251], v16 offset:1248
v_mfma_f32_16x16x32_bf16 v[52:55], v[244:247], v[220:223], v[52:55]
v_mfma_f32_16x16x32_bf16 v[52:55], v[224:227], v[212:215], v[52:55]
v_mfma_f32_16x16x32_bf16 v[52:55], v[216:219], v[204:207], v[52:55]
v_mfma_f32_16x16x32_bf16 v[52:55], v[208:211], v[196:199], v[52:55]
ds_read_b128 v[252:255], v16 offset:1376
v_mfma_f32_16x16x32_bf16 v[56:59], v[216:219], v[196:199], v[56:59]
s_barrier
ds_read_b64_tr_b16 v[88:89], v22 offset:49152
v_mfma_f32_16x16x32_bf16 v[56:59], v[224:227], v[204:207], v[56:59]
ds_read_b64_tr_b16 v[90:91], v22 offset:49664
v_mfma_f32_16x16x32_bf16 v[56:59], v[244:247], v[212:215], v[56:59]
ds_read_b64_tr_b16 v[92:93], v22 offset:53248
s_waitcnt lgkmcnt(4)
v_mfma_f32_16x16x32_bf16 v[56:59], v[248:251], v[220:223], v[56:59]
ds_read_b64_tr_b16 v[94:95], v22 offset:53760
v_mfma_f32_16x16x32_bf16 v[40:43], v[248:251], v[228:231], v[40:43]
ds_read_b64_tr_b16 v[108:109], v22 offset:57344
v_mfma_f32_16x16x32_bf16 v[40:43], v[244:247], v[232:235], v[40:43]
ds_read_b64_tr_b16 v[110:111], v22 offset:57856
v_mfma_f32_16x16x32_bf16 v[40:43], v[224:227], v[236:239], v[40:43]
ds_read_b64_tr_b16 v[112:113], v22 offset:61440
v_mfma_f32_16x16x32_bf16 v[40:43], v[216:219], v[240:243], v[40:43]
ds_read_b64_tr_b16 v[114:115], v22 offset:61952
v_mfma_f32_16x16x32_bf16 v[44:47], v[224:227], v[240:243], v[44:47]
ds_read_b128 v[96:99], v16 offset:1504
v_mfma_f32_16x16x32_bf16 v[44:47], v[244:247], v[236:239], v[44:47]
ds_read_b64_tr_b16 v[120:121], v19 offset:61440
v_mfma_f32_16x16x32_bf16 v[44:47], v[248:251], v[232:235], v[44:47]
ds_read_b64_tr_b16 v[122:123], v19 offset:61952
s_waitcnt lgkmcnt(4)
v_mfma_f32_16x16x32_bf16 v[44:47], v[252:255], v[228:231], v[44:47]
ds_read_b64_tr_b16 v[100:101], v19 offset:57344
v_mfma_f32_16x16x32_bf16 v[60:63], v[252:255], v[220:223], v[60:63]
ds_read_b64_tr_b16 v[102:103], v19 offset:57856
v_mfma_f32_16x16x32_bf16 v[60:63], v[248:251], v[212:215], v[60:63]
ds_read_b64_tr_b16 v[104:105], v19 offset:53248
v_mfma_f32_16x16x32_bf16 v[60:63], v[244:247], v[204:207], v[60:63]
ds_read_b64_tr_b16 v[106:107], v19 offset:53760
v_mfma_f32_16x16x32_bf16 v[60:63], v[224:227], v[196:199], v[60:63]
ds_read_b64_tr_b16 v[136:137], v19 offset:49152
v_mfma_f32_16x16x32_bf16 v[48:51], v[244:247], v[88:91], v[48:51]
ds_read_b64_tr_b16 v[138:139], v19 offset:49664
v_mfma_f32_16x16x32_bf16 v[48:51], v[248:251], v[92:95], v[48:51]
v_mfma_f32_16x16x32_bf16 v[48:51], v[252:255], v[108:111], v[48:51]
s_waitcnt lgkmcnt(2)
v_mfma_f32_16x16x32_bf16 v[48:51], v[96:99], v[112:115], v[48:51]
ds_read_b128 v[132:135], v16 offset:2176
v_mfma_f32_16x16x32_bf16 v[32:35], v[96:99], v[120:123], v[32:35]
v_mfma_f32_16x16x32_bf16 v[32:35], v[252:255], v[100:103], v[32:35]
v_mfma_f32_16x16x32_bf16 v[32:35], v[248:251], v[104:107], v[32:35]
s_waitcnt lgkmcnt(1)
v_mfma_f32_16x16x32_bf16 v[32:35], v[244:247], v[136:139], v[32:35]
v_mfma_f32_16x16x32_bf16 v[36:39], v[248:251], v[136:139], v[36:39]
v_mfma_f32_16x16x32_bf16 v[36:39], v[252:255], v[104:107], v[36:39]
v_mfma_f32_16x16x32_bf16 v[36:39], v[96:99], v[100:103], v[36:39]
s_waitcnt lgkmcnt(0)
v_mfma_f32_16x16x32_bf16 v[36:39], v[132:135], v[120:123], v[36:39]
ds_read_b128 v[128:131], v16 offset:2304
v_mfma_f32_16x16x32_bf16 v[52:55], v[132:135], v[112:115], v[52:55]
v_mfma_f32_16x16x32_bf16 v[52:55], v[96:99], v[108:111], v[52:55]
v_mfma_f32_16x16x32_bf16 v[52:55], v[252:255], v[92:95], v[52:55]
ds_read_b128 v[124:127], v16 offset:2432
v_mfma_f32_16x16x32_bf16 v[52:55], v[248:251], v[88:91], v[52:55]
ds_read_b64_tr_b16 v[116:117], v23 offset:0
v_mfma_f32_16x16x32_bf16 v[56:59], v[252:255], v[88:91], v[56:59]
ds_read_b64_tr_b16 v[118:119], v23 offset:512
v_mfma_f32_16x16x32_bf16 v[56:59], v[96:99], v[92:95], v[56:59]
ds_read_b128 v[140:143], v16 offset:19008
v_mfma_f32_16x16x32_bf16 v[56:59], v[132:135], v[108:111], v[56:59]
ds_read_b64_tr_b16 v[160:161], v23 offset:4096
s_waitcnt lgkmcnt(4)
v_mfma_f32_16x16x32_bf16 v[56:59], v[128:131], v[112:115], v[56:59]
ds_read_b64_tr_b16 v[162:163], v23 offset:4608
v_mfma_f32_16x16x32_bf16 v[40:43], v[128:131], v[120:123], v[40:43]
ds_read_b128 v[156:159], v16 offset:19136
v_mfma_f32_16x16x32_bf16 v[40:43], v[132:135], v[100:103], v[40:43]
ds_read_b64_tr_b16 v[152:153], v23 offset:8192
v_mfma_f32_16x16x32_bf16 v[40:43], v[96:99], v[104:107], v[40:43]
ds_read_b64_tr_b16 v[154:155], v23 offset:8704
v_mfma_f32_16x16x32_bf16 v[40:43], v[252:255], v[136:139], v[40:43]
ds_read_b128 v[148:151], v16 offset:19264
v_mfma_f32_16x16x32_bf16 v[44:47], v[96:99], v[136:139], v[44:47]
ds_read_b64_tr_b16 v[144:145], v20 offset:8192
v_mfma_f32_16x16x32_bf16 v[44:47], v[132:135], v[104:107], v[44:47]
ds_read_b64_tr_b16 v[146:147], v20 offset:8704
v_mfma_f32_16x16x32_bf16 v[44:47], v[128:131], v[100:103], v[44:47]
ds_read_b64_tr_b16 v[164:165], v20 offset:4096
v_mfma_f32_16x16x32_bf16 v[44:47], v[124:127], v[120:123], v[44:47]
ds_read_b64_tr_b16 v[166:167], v20 offset:4608
v_mfma_f32_16x16x32_bf16 v[60:63], v[124:127], v[112:115], v[60:63]
ds_read_b64_tr_b16 v[168:169], v20 offset:0
v_mfma_f32_16x16x32_bf16 v[60:63], v[128:131], v[108:111], v[60:63]
ds_read_b64_tr_b16 v[170:171], v20 offset:512
v_mfma_f32_16x16x32_bf16 v[60:63], v[132:135], v[92:95], v[60:63]
v_mfma_f32_16x16x32_bf16 v[60:63], v[96:99], v[88:91], v[60:63]
s_waitcnt lgkmcnt(2)
v_mfma_f32_16x16x32_bf16 v[48:51], v[140:143], v[116:119], v[48:51]
ds_read_b128 v[184:187], v16 offset:19392
v_mfma_f32_16x16x32_bf16 v[48:51], v[156:159], v[160:163], v[48:51]
v_mfma_f32_16x16x32_bf16 v[48:51], v[148:151], v[152:155], v[48:51]
v_mfma_f32_16x16x32_bf16 v[32:35], v[148:151], v[144:147], v[32:35]
v_mfma_f32_16x16x32_bf16 v[32:35], v[156:159], v[164:167], v[32:35]
s_waitcnt lgkmcnt(0)
v_mfma_f32_16x16x32_bf16 v[32:35], v[140:143], v[168:171], v[32:35]
v_mfma_f32_16x16x32_bf16 v[36:39], v[156:159], v[168:171], v[36:39]
ds_read_b128 v[180:183], v16 offset:20064
v_mfma_f32_16x16x32_bf16 v[36:39], v[148:151], v[164:167], v[36:39]
ds_read_b128 v[192:195], v16 offset:20192
v_mfma_f32_16x16x32_bf16 v[36:39], v[184:187], v[144:147], v[36:39]
s_barrier
ds_read_b64_tr_b16 v[176:177], v23 offset:12288
v_mfma_f32_16x16x32_bf16 v[52:55], v[184:187], v[152:155], v[52:55]
ds_read_b64_tr_b16 v[178:179], v23 offset:12800
v_mfma_f32_16x16x32_bf16 v[52:55], v[148:151], v[160:163], v[52:55]
ds_read_b64_tr_b16 v[188:189], v23 offset:16384
v_mfma_f32_16x16x32_bf16 v[52:55], v[156:159], v[116:119], v[52:55]
ds_read_b64_tr_b16 v[190:191], v23 offset:16896
v_mfma_f32_16x16x32_bf16 v[56:59], v[148:151], v[116:119], v[56:59]
ds_read_b64_tr_b16 v[172:173], v22 offset:0
v_mfma_f32_16x16x32_bf16 v[56:59], v[184:187], v[160:163], v[56:59]
ds_read_b64_tr_b16 v[174:175], v22 offset:512
s_waitcnt lgkmcnt(4)
v_mfma_f32_16x16x32_bf16 v[56:59], v[180:183], v[152:155], v[56:59]
ds_read_b64_tr_b16 v[200:201], v22 offset:4096
v_mfma_f32_16x16x32_bf16 v[40:43], v[180:183], v[144:147], v[40:43]
ds_read_b64_tr_b16 v[202:203], v22 offset:4608
v_mfma_f32_16x16x32_bf16 v[40:43], v[184:187], v[164:167], v[40:43]
ds_read_b128 v[208:211], v16 offset:20320
v_mfma_f32_16x16x32_bf16 v[40:43], v[148:151], v[168:171], v[40:43]
ds_read_b64_tr_b16 v[216:217], v19 offset:4096
v_mfma_f32_16x16x32_bf16 v[44:47], v[184:187], v[168:171], v[44:47]
ds_read_b64_tr_b16 v[218:219], v19 offset:4608
v_mfma_f32_16x16x32_bf16 v[44:47], v[180:183], v[164:167], v[44:47]
ds_read_b64_tr_b16 v[240:241], v19 offset:0
v_mfma_f32_16x16x32_bf16 v[44:47], v[192:195], v[144:147], v[44:47]
ds_read_b64_tr_b16 v[242:243], v19 offset:512
v_mfma_f32_16x16x32_bf16 v[60:63], v[192:195], v[152:155], v[60:63]
ds_read_b64_tr_b16 v[236:237], v20 offset:16384
v_mfma_f32_16x16x32_bf16 v[60:63], v[180:183], v[160:163], v[60:63]
ds_read_b64_tr_b16 v[238:239], v20 offset:16896
v_mfma_f32_16x16x32_bf16 v[60:63], v[184:187], v[116:119], v[60:63]
ds_read_b64_tr_b16 v[232:233], v20 offset:12288
v_mfma_f32_16x16x32_bf16 v[48:51], v[184:187], v[176:179], v[48:51]
ds_read_b64_tr_b16 v[234:235], v20 offset:12800
s_waitcnt lgkmcnt(4)
v_mfma_f32_16x16x32_bf16 v[48:51], v[180:183], v[188:191], v[48:51]
v_mfma_f32_16x16x32_bf16 v[48:51], v[192:195], v[172:175], v[48:51]
v_mfma_f32_16x16x32_bf16 v[48:51], v[208:211], v[200:203], v[48:51]
ds_read_b128 v[228:231], v16 offset:20448
v_mfma_f32_16x16x32_bf16 v[32:35], v[208:211], v[216:219], v[32:35]
v_mfma_f32_16x16x32_bf16 v[32:35], v[192:195], v[240:243], v[32:35]
s_waitcnt lgkmcnt(1)
v_mfma_f32_16x16x32_bf16 v[32:35], v[180:183], v[236:239], v[32:35]
v_mfma_f32_16x16x32_bf16 v[32:35], v[184:187], v[232:235], v[32:35]
v_mfma_f32_16x16x32_bf16 v[36:39], v[180:183], v[232:235], v[36:39]
v_mfma_f32_16x16x32_bf16 v[36:39], v[192:195], v[236:239], v[36:39]
v_mfma_f32_16x16x32_bf16 v[36:39], v[208:211], v[240:243], v[36:39]
s_waitcnt lgkmcnt(0)
v_mfma_f32_16x16x32_bf16 v[36:39], v[228:231], v[216:219], v[36:39]
ds_read_b128 v[220:223], v16 offset:21120
v_mfma_f32_16x16x32_bf16 v[52:55], v[228:231], v[200:203], v[52:55]
v_mfma_f32_16x16x32_bf16 v[52:55], v[208:211], v[172:175], v[52:55]
v_mfma_f32_16x16x32_bf16 v[52:55], v[192:195], v[188:191], v[52:55]
v_mfma_f32_16x16x32_bf16 v[52:55], v[180:183], v[176:179], v[52:55]
v_mfma_f32_16x16x32_bf16 v[56:59], v[192:195], v[176:179], v[56:59]
v_mfma_f32_16x16x32_bf16 v[56:59], v[208:211], v[188:191], v[56:59]
v_mfma_f32_16x16x32_bf16 v[56:59], v[228:231], v[172:175], v[56:59]
s_waitcnt lgkmcnt(0)
v_mfma_f32_16x16x32_bf16 v[56:59], v[220:223], v[200:203], v[56:59]
ds_read_b128 v[212:215], v16 offset:21248
v_mfma_f32_16x16x32_bf16 v[40:43], v[220:223], v[216:219], v[40:43]
ds_read_b64_tr_b16 v[204:205], v22 offset:8192
v_mfma_f32_16x16x32_bf16 v[40:43], v[228:231], v[240:243], v[40:43]
ds_read_b64_tr_b16 v[206:207], v22 offset:8704
v_mfma_f32_16x16x32_bf16 v[40:43], v[208:211], v[236:239], v[40:43]
ds_read_b128 v[224:227], v16 offset:19072
v_mfma_f32_16x16x32_bf16 v[40:43], v[192:195], v[232:235], v[40:43]
ds_read_b128 v[196:199], v16 offset:19200
v_mfma_f32_16x16x32_bf16 v[44:47], v[208:211], v[232:235], v[44:47]
ds_read_b128 v[244:247], v16 offset:19328
v_mfma_f32_16x16x32_bf16 v[44:47], v[228:231], v[236:239], v[44:47]
ds_read_b128 v[248:251], v16 offset:19456
v_mfma_f32_16x16x32_bf16 v[44:47], v[220:223], v[240:243], v[44:47]
ds_read_b64_tr_b16 v[252:253], v19 offset:8192
s_waitcnt lgkmcnt(4)
v_mfma_f32_16x16x32_bf16 v[44:47], v[212:215], v[216:219], v[44:47]
ds_read_b64_tr_b16 v[254:255], v19 offset:8704
v_mfma_f32_16x16x32_bf16 v[60:63], v[212:215], v[200:203], v[60:63]
s_barrier
ds_read_b64_tr_b16 v[136:137], v22 offset:12288
v_mfma_f32_16x16x32_bf16 v[60:63], v[220:223], v[172:175], v[60:63]
ds_read_b64_tr_b16 v[138:139], v22 offset:12800
v_mfma_f32_16x16x32_bf16 v[60:63], v[228:231], v[188:191], v[60:63]
ds_read_b64_tr_b16 v[104:105], v22 offset:16384
v_mfma_f32_16x16x32_bf16 v[60:63], v[208:211], v[176:179], v[60:63]
ds_read_b64_tr_b16 v[106:107], v22 offset:16896
v_mfma_f32_16x16x32_bf16 v[48:51], v[224:227], v[204:207], v[48:51]
ds_read_b64_tr_b16 v[100:101], v22 offset:20480
s_waitcnt lgkmcnt(4)
v_mfma_f32_16x16x32_bf16 v[52:55], v[196:199], v[204:207], v[52:55]
ds_read_b64_tr_b16 v[102:103], v22 offset:20992
v_mfma_f32_16x16x32_bf16 v[56:59], v[244:247], v[204:207], v[56:59]
ds_read_b64_tr_b16 v[120:121], v19 offset:20480
v_mfma_f32_16x16x32_bf16 v[60:63], v[248:251], v[204:207], v[60:63]
ds_read_b64_tr_b16 v[122:123], v19 offset:20992
v_mfma_f32_16x16x32_bf16 v[44:47], v[248:251], v[252:255], v[44:47]
ds_read_b64_tr_b16 v[124:125], v19 offset:16384
v_mfma_f32_16x16x32_bf16 v[40:43], v[244:247], v[252:255], v[40:43]
ds_read_b64_tr_b16 v[126:127], v19 offset:16896
v_mfma_f32_16x16x32_bf16 v[36:39], v[196:199], v[252:255], v[36:39]
ds_read_b64_tr_b16 v[112:113], v19 offset:12288
v_mfma_f32_16x16x32_bf16 v[32:35], v[224:227], v[252:255], v[32:35]
ds_read_b64_tr_b16 v[114:115], v19 offset:12800
s_waitcnt lgkmcnt(4)
v_mfma_f32_16x16x32_bf16 v[48:51], v[196:199], v[136:139], v[48:51]
ds_read_b128 v[128:131], v16 offset:20128
v_mfma_f32_16x16x32_bf16 v[48:51], v[244:247], v[104:107], v[48:51]
v_mfma_f32_16x16x32_bf16 v[48:51], v[248:251], v[100:103], v[48:51]
v_mfma_f32_16x16x32_bf16 v[32:35], v[248:251], v[120:123], v[32:35]
s_waitcnt lgkmcnt(1)
v_mfma_f32_16x16x32_bf16 v[32:35], v[244:247], v[124:127], v[32:35]
v_mfma_f32_16x16x32_bf16 v[32:35], v[196:199], v[112:115], v[32:35]
v_mfma_f32_16x16x32_bf16 v[36:39], v[244:247], v[112:115], v[36:39]
ds_read_b128 v[108:111], v16 offset:20256
v_mfma_f32_16x16x32_bf16 v[36:39], v[248:251], v[124:127], v[36:39]
s_waitcnt lgkmcnt(1)
v_mfma_f32_16x16x32_bf16 v[36:39], v[128:131], v[120:123], v[36:39]
v_mfma_f32_16x16x32_bf16 v[52:55], v[128:131], v[100:103], v[52:55]
ds_read_b128 v[132:135], v16 offset:20384
v_mfma_f32_16x16x32_bf16 v[52:55], v[248:251], v[104:107], v[52:55]
ds_read_b64_tr_b16 v[92:93], v22 offset:24576
v_mfma_f32_16x16x32_bf16 v[52:55], v[244:247], v[136:139], v[52:55]
ds_read_b64_tr_b16 v[94:95], v22 offset:25088
v_mfma_f32_16x16x32_bf16 v[56:59], v[248:251], v[136:139], v[56:59]
ds_read_b64_tr_b16 v[96:97], v22 offset:28672
v_mfma_f32_16x16x32_bf16 v[56:59], v[128:131], v[104:107], v[56:59]
ds_read_b64_tr_b16 v[98:99], v22 offset:29184
s_waitcnt lgkmcnt(4)
v_mfma_f32_16x16x32_bf16 v[56:59], v[108:111], v[100:103], v[56:59]
ds_read_b64_tr_b16 v[88:89], v22 offset:32768
v_mfma_f32_16x16x32_bf16 v[40:43], v[108:111], v[120:123], v[40:43]
ds_read_b64_tr_b16 v[90:91], v22 offset:33280
v_mfma_f32_16x16x32_bf16 v[40:43], v[128:131], v[124:127], v[40:43]
ds_read_b64_tr_b16 v[140:141], v19 offset:32768
v_mfma_f32_16x16x32_bf16 v[40:43], v[248:251], v[112:115], v[40:43]
ds_read_b64_tr_b16 v[142:143], v19 offset:33280
v_mfma_f32_16x16x32_bf16 v[44:47], v[128:131], v[112:115], v[44:47]
ds_read_b64_tr_b16 v[156:157], v19 offset:28672
v_mfma_f32_16x16x32_bf16 v[44:47], v[108:111], v[124:127], v[44:47]
ds_read_b64_tr_b16 v[158:159], v19 offset:29184
v_mfma_f32_16x16x32_bf16 v[44:47], v[132:135], v[120:123], v[44:47]
ds_read_b64_tr_b16 v[148:149], v19 offset:24576
v_mfma_f32_16x16x32_bf16 v[60:63], v[132:135], v[100:103], v[60:63]
ds_read_b64_tr_b16 v[150:151], v19 offset:25088
v_mfma_f32_16x16x32_bf16 v[60:63], v[108:111], v[104:107], v[60:63]
v_mfma_f32_16x16x32_bf16 v[60:63], v[128:131], v[136:139], v[60:63]
s_waitcnt lgkmcnt(2)
v_mfma_f32_16x16x32_bf16 v[48:51], v[128:131], v[92:95], v[48:51]
ds_read_b128 v[168:171], v16 offset:20512
v_mfma_f32_16x16x32_bf16 v[48:51], v[108:111], v[96:99], v[48:51]
v_mfma_f32_16x16x32_bf16 v[48:51], v[132:135], v[88:91], v[48:51]
v_mfma_f32_16x16x32_bf16 v[32:35], v[132:135], v[140:143], v[32:35]
v_mfma_f32_16x16x32_bf16 v[32:35], v[108:111], v[156:159], v[32:35]
s_waitcnt lgkmcnt(0)
v_mfma_f32_16x16x32_bf16 v[32:35], v[128:131], v[148:151], v[32:35]
v_mfma_f32_16x16x32_bf16 v[36:39], v[108:111], v[148:151], v[36:39]
ds_read_b128 v[164:167], v16 offset:21184
v_mfma_f32_16x16x32_bf16 v[36:39], v[132:135], v[156:159], v[36:39]
v_mfma_f32_16x16x32_bf16 v[36:39], v[168:171], v[140:143], v[36:39]
v_mfma_f32_16x16x32_bf16 v[52:55], v[168:171], v[88:91], v[52:55]
ds_read_b128 v[144:147], v16 offset:21312
v_mfma_f32_16x16x32_bf16 v[52:55], v[132:135], v[96:99], v[52:55]
s_barrier
ds_read_b64_tr_b16 v[152:153], v22 offset:36864
v_mfma_f32_16x16x32_bf16 v[52:55], v[108:111], v[92:95], v[52:55]
ds_read_b64_tr_b16 v[154:155], v22 offset:37376
v_mfma_f32_16x16x32_bf16 v[56:59], v[132:135], v[92:95], v[56:59]
ds_read_b128 v[160:163], v16 offset:38016
v_mfma_f32_16x16x32_bf16 v[56:59], v[168:171], v[96:99], v[56:59]
ds_read_b64_tr_b16 v[116:117], v22 offset:40960
s_waitcnt lgkmcnt(4)
v_mfma_f32_16x16x32_bf16 v[56:59], v[164:167], v[88:91], v[56:59]
ds_read_b64_tr_b16 v[118:119], v22 offset:41472
v_mfma_f32_16x16x32_bf16 v[40:43], v[164:167], v[140:143], v[40:43]
ds_read_b128 v[184:187], v16 offset:38144
v_mfma_f32_16x16x32_bf16 v[40:43], v[168:171], v[156:159], v[40:43]
ds_read_b64_tr_b16 v[180:181], v19 offset:40960
v_mfma_f32_16x16x32_bf16 v[40:43], v[132:135], v[148:151], v[40:43]
ds_read_b64_tr_b16 v[182:183], v19 offset:41472
v_mfma_f32_16x16x32_bf16 v[44:47], v[168:171], v[148:151], v[44:47]
ds_read_b64_tr_b16 v[192:193], v19 offset:36864
v_mfma_f32_16x16x32_bf16 v[44:47], v[164:167], v[156:159], v[44:47]
ds_read_b64_tr_b16 v[194:195], v19 offset:37376
v_mfma_f32_16x16x32_bf16 v[44:47], v[144:147], v[140:143], v[44:47]
v_mfma_f32_16x16x32_bf16 v[60:63], v[144:147], v[88:91], v[60:63]
ds_read_b128 v[232:235], v16 offset:38272
v_mfma_f32_16x16x32_bf16 v[60:63], v[164:167], v[96:99], v[60:63]
v_mfma_f32_16x16x32_bf16 v[60:63], v[168:171], v[92:95], v[60:63]
ds_read_b128 v[236:239], v16 offset:38400
L_pad1:
s_cbranch_execz L_compute
s_waitcnt lgkmcnt(2)
v_mfma_f32_16x16x32_bf16 v[48:51], v[160:163], v[152:155], v[48:51]
ds_read_b128 v[240:243], v16 offset:39072
v_mfma_f32_16x16x32_bf16 v[48:51], v[184:187], v[116:119], v[48:51]
s_barrier
ds_read_b64_tr_b16 v[216:217], v22 offset:45056
v_mfma_f32_16x16x32_bf16 v[32:35], v[184:187], v[180:183], v[32:35]
ds_read_b64_tr_b16 v[218:219], v22 offset:45568
v_mfma_f32_16x16x32_bf16 v[32:35], v[160:163], v[192:195], v[32:35]
ds_read_b64_tr_b16 v[212:213], v22 offset:49152
v_mfma_f32_16x16x32_bf16 v[36:39], v[184:187], v[192:195], v[36:39]
ds_read_b64_tr_b16 v[214:215], v22 offset:49664
s_waitcnt lgkmcnt(4)
v_mfma_f32_16x16x32_bf16 v[36:39], v[232:235], v[180:183], v[36:39]
ds_read_b64_tr_b16 v[200:201], v22 offset:53248
v_mfma_f32_16x16x32_bf16 v[52:55], v[232:235], v[116:119], v[52:55]
ds_read_b64_tr_b16 v[202:203], v22 offset:53760
v_mfma_f32_16x16x32_bf16 v[52:55], v[184:187], v[152:155], v[52:55]
ds_read_b64_tr_b16 v[220:221], v22 offset:57344
v_mfma_f32_16x16x32_bf16 v[56:59], v[232:235], v[152:155], v[56:59]
ds_read_b64_tr_b16 v[222:223], v22 offset:57856
v_mfma_f32_16x16x32_bf16 v[56:59], v[236:239], v[116:119], v[56:59]
ds_read_b128 v[172:175], v16 offset:39200
v_mfma_f32_16x16x32_bf16 v[40:43], v[236:239], v[180:183], v[40:43]
ds_read_b64_tr_b16 v[228:229], v19 offset:57344
v_mfma_f32_16x16x32_bf16 v[40:43], v[232:235], v[192:195], v[40:43]
ds_read_b64_tr_b16 v[230:231], v19 offset:57856
v_mfma_f32_16x16x32_bf16 v[44:47], v[236:239], v[192:195], v[44:47]
ds_read_b64_tr_b16 v[188:189], v19 offset:53248
v_mfma_f32_16x16x32_bf16 v[44:47], v[240:243], v[180:183], v[44:47]
ds_read_b64_tr_b16 v[190:191], v19 offset:53760
v_mfma_f32_16x16x32_bf16 v[60:63], v[240:243], v[116:119], v[60:63]
ds_read_b64_tr_b16 v[208:209], v19 offset:49152
v_mfma_f32_16x16x32_bf16 v[60:63], v[236:239], v[152:155], v[60:63]
ds_read_b64_tr_b16 v[210:211], v19 offset:49664
s_waitcnt lgkmcnt(4)
v_mfma_f32_16x16x32_bf16 v[48:51], v[232:235], v[216:219], v[48:51]
ds_read_b64_tr_b16 v[176:177], v19 offset:45056
v_mfma_f32_16x16x32_bf16 v[48:51], v[236:239], v[212:215], v[48:51]
ds_read_b64_tr_b16 v[178:179], v19 offset:45568
v_mfma_f32_16x16x32_bf16 v[48:51], v[240:243], v[200:203], v[48:51]
v_mfma_f32_16x16x32_bf16 v[48:51], v[172:175], v[220:223], v[48:51]
ds_read_b128 v[204:207], v16 offset:39328
v_mfma_f32_16x16x32_bf16 v[32:35], v[172:175], v[228:231], v[32:35]
s_waitcnt lgkmcnt(2)
v_mfma_f32_16x16x32_bf16 v[32:35], v[240:243], v[188:191], v[32:35]
v_mfma_f32_16x16x32_bf16 v[32:35], v[236:239], v[208:211], v[32:35]
s_waitcnt lgkmcnt(1)
v_mfma_f32_16x16x32_bf16 v[32:35], v[232:235], v[176:179], v[32:35]
v_mfma_f32_16x16x32_bf16 v[36:39], v[236:239], v[176:179], v[36:39]
v_mfma_f32_16x16x32_bf16 v[36:39], v[240:243], v[208:211], v[36:39]
v_mfma_f32_16x16x32_bf16 v[36:39], v[172:175], v[188:191], v[36:39]
s_waitcnt lgkmcnt(0)
v_mfma_f32_16x16x32_bf16 v[36:39], v[204:207], v[228:231], v[36:39]
ds_read_b128 v[224:227], v16 offset:39456
v_mfma_f32_16x16x32_bf16 v[52:55], v[204:207], v[220:223], v[52:55]
v_mfma_f32_16x16x32_bf16 v[52:55], v[172:175], v[200:203], v[52:55]
v_mfma_f32_16x16x32_bf16 v[52:55], v[240:243], v[212:215], v[52:55]
v_mfma_f32_16x16x32_bf16 v[52:55], v[236:239], v[216:219], v[52:55]
v_mfma_f32_16x16x32_bf16 v[56:59], v[240:243], v[216:219], v[56:59]
v_mfma_f32_16x16x32_bf16 v[56:59], v[172:175], v[212:215], v[56:59]
v_mfma_f32_16x16x32_bf16 v[56:59], v[204:207], v[200:203], v[56:59]
s_waitcnt lgkmcnt(0)
v_mfma_f32_16x16x32_bf16 v[56:59], v[224:227], v[220:223], v[56:59]
ds_read_b128 v[252:255], v16 offset:40128
v_mfma_f32_16x16x32_bf16 v[40:43], v[224:227], v[228:231], v[40:43]
s_barrier
ds_read_b64_tr_b16 v[196:197], v22 offset:61440
v_mfma_f32_16x16x32_bf16 v[40:43], v[204:207], v[188:191], v[40:43]
ds_read_b64_tr_b16 v[198:199], v22 offset:61952
v_mfma_f32_16x16x32_bf16 v[40:43], v[172:175], v[208:211], v[40:43]
ds_read_b64_tr_b16 v[244:245], v23 offset:0
v_mfma_f32_16x16x32_bf16 v[40:43], v[240:243], v[176:179], v[40:43]
ds_read_b64_tr_b16 v[246:247], v23 offset:512
v_mfma_f32_16x16x32_bf16 v[44:47], v[172:175], v[176:179], v[44:47]
ds_read_b64_tr_b16 v[248:249], v20 offset:0
v_mfma_f32_16x16x32_bf16 v[44:47], v[204:207], v[208:211], v[44:47]
ds_read_b64_tr_b16 v[250:251], v20 offset:512
v_mfma_f32_16x16x32_bf16 v[44:47], v[224:227], v[188:191], v[44:47]
ds_read_b64_tr_b16 v[112:113], v19 offset:61440
s_waitcnt lgkmcnt(4)
v_mfma_f32_16x16x32_bf16 v[44:47], v[252:255], v[228:231], v[44:47]
ds_read_b64_tr_b16 v[114:115], v19 offset:61952
v_mfma_f32_16x16x32_bf16 v[60:63], v[252:255], v[220:223], v[60:63]
v_mfma_f32_16x16x32_bf16 v[60:63], v[224:227], v[200:203], v[60:63]
v_mfma_f32_16x16x32_bf16 v[60:63], v[204:207], v[212:215], v[60:63]
v_mfma_f32_16x16x32_bf16 v[60:63], v[172:175], v[216:219], v[60:63]
v_mfma_f32_16x16x32_bf16 v[48:51], v[204:207], v[196:199], v[48:51]
s_waitcnt lgkmcnt(0)
v_mfma_f32_16x16x32_bf16 v[48:51], v[224:227], v[244:247], v[48:51]
ds_read_b128 v[124:127], v16 offset:40256
v_mfma_f32_16x16x32_bf16 v[32:35], v[224:227], v[248:251], v[32:35]
v_mfma_f32_16x16x32_bf16 v[32:35], v[204:207], v[112:115], v[32:35]
ds_read_b128 v[120:123], v16 offset:40384
v_mfma_f32_16x16x32_bf16 v[36:39], v[224:227], v[112:115], v[36:39]
ds_read_b64_tr_b16 v[100:101], v23 offset:4096
v_mfma_f32_16x16x32_bf16 v[36:39], v[252:255], v[248:251], v[36:39]
ds_read_b64_tr_b16 v[102:103], v23 offset:4608
v_mfma_f32_16x16x32_bf16 v[52:55], v[252:255], v[244:247], v[52:55]
ds_read_b128 v[104:107], v16 offset:38080
v_mfma_f32_16x16x32_bf16 v[52:55], v[224:227], v[196:199], v[52:55]
ds_read_b64_tr_b16 v[136:137], v23 offset:8192
v_mfma_f32_16x16x32_bf16 v[56:59], v[252:255], v[196:199], v[56:59]
ds_read_b64_tr_b16 v[138:139], v23 offset:8704
s_waitcnt lgkmcnt(4)
v_mfma_f32_16x16x32_bf16 v[56:59], v[124:127], v[244:247], v[56:59]
ds_read_b128 v[128:131], v16 offset:38208
v_mfma_f32_16x16x32_bf16 v[40:43], v[124:127], v[248:251], v[40:43]
ds_read_b128 v[108:111], v16 offset:38336
v_mfma_f32_16x16x32_bf16 v[40:43], v[252:255], v[112:115], v[40:43]
v_mfma_f32_16x16x32_bf16 v[44:47], v[124:127], v[112:115], v[44:47]
ds_read_b128 v[132:135], v16 offset:38464
v_mfma_f32_16x16x32_bf16 v[44:47], v[120:123], v[248:251], v[44:47]
ds_read_b128 v[148:151], v16 offset:39136
v_mfma_f32_16x16x32_bf16 v[60:63], v[120:123], v[244:247], v[60:63]
ds_read_b64_tr_b16 v[156:157], v23 offset:12288
v_mfma_f32_16x16x32_bf16 v[60:63], v[124:127], v[196:199], v[60:63]
ds_read_b64_tr_b16 v[158:159], v23 offset:12800
s_waitcnt lgkmcnt(4)
v_mfma_f32_16x16x32_bf16 v[48:51], v[104:107], v[100:103], v[48:51]
s_barrier
ds_read_b64_tr_b16 v[140:141], v23 offset:16384
v_mfma_f32_16x16x32_bf16 v[48:51], v[128:131], v[136:139], v[48:51]
ds_read_b64_tr_b16 v[142:143], v23 offset:16896
v_mfma_f32_16x16x32_bf16 v[52:55], v[108:111], v[136:139], v[52:55]
v_mfma_f32_16x16x32_bf16 v[52:55], v[128:131], v[100:103], v[52:55]
v_mfma_f32_16x16x32_bf16 v[56:59], v[108:111], v[100:103], v[56:59]
ds_read_b128 v[144:147], v16 offset:39264
s_waitcnt lgkmcnt(2)
v_mfma_f32_16x16x32_bf16 v[56:59], v[132:135], v[136:139], v[56:59]
ds_read_b128 v[88:91], v16 offset:39392
v_mfma_f32_16x16x32_bf16 v[60:63], v[148:151], v[136:139], v[60:63]
ds_read_b64_tr_b16 v[164:165], v22 offset:0
v_mfma_f32_16x16x32_bf16 v[60:63], v[132:135], v[100:103], v[60:63]
ds_read_b64_tr_b16 v[166:167], v22 offset:512
v_mfma_f32_16x16x32_bf16 v[48:51], v[108:111], v[156:159], v[48:51]
ds_read_b64_tr_b16 v[96:97], v22 offset:4096
s_waitcnt lgkmcnt(4)
v_mfma_f32_16x16x32_bf16 v[48:51], v[132:135], v[140:143], v[48:51]
ds_read_b64_tr_b16 v[98:99], v22 offset:4608
v_mfma_f32_16x16x32_bf16 v[52:55], v[148:151], v[140:143], v[52:55]
v_mfma_f32_16x16x32_bf16 v[52:55], v[132:135], v[156:159], v[52:55]
v_mfma_f32_16x16x32_bf16 v[56:59], v[148:151], v[156:159], v[56:59]
ds_read_b128 v[168:171], v16 offset:39520
v_mfma_f32_16x16x32_bf16 v[56:59], v[144:147], v[140:143], v[56:59]
ds_read_b128 v[92:95], v16 offset:40192
s_waitcnt lgkmcnt(2)
v_mfma_f32_16x16x32_bf16 v[60:63], v[88:91], v[140:143], v[60:63]
ds_read_b64_tr_b16 v[160:161], v22 offset:8192
v_mfma_f32_16x16x32_bf16 v[60:63], v[144:147], v[156:159], v[60:63]
ds_read_b64_tr_b16 v[162:163], v22 offset:8704
v_mfma_f32_16x16x32_bf16 v[48:51], v[148:151], v[164:167], v[48:51]
ds_read_b64_tr_b16 v[184:185], v22 offset:12288
v_mfma_f32_16x16x32_bf16 v[48:51], v[144:147], v[96:99], v[48:51]
ds_read_b64_tr_b16 v[186:187], v22 offset:12800
v_mfma_f32_16x16x32_bf16 v[52:55], v[88:91], v[96:99], v[52:55]
ds_read_b128 v[192:195], v16 offset:40320
v_mfma_f32_16x16x32_bf16 v[52:55], v[144:147], v[164:167], v[52:55]
ds_read_b128 v[180:183], v16 offset:40448
v_mfma_f32_16x16x32_bf16 v[56:59], v[88:91], v[164:167], v[56:59]
s_barrier
ds_read_b64_tr_b16 v[116:117], v22 offset:16384
s_waitcnt lgkmcnt(4)
v_mfma_f32_16x16x32_bf16 v[56:59], v[168:171], v[96:99], v[56:59]
ds_read_b64_tr_b16 v[118:119], v22 offset:16896
v_mfma_f32_16x16x32_bf16 v[60:63], v[92:95], v[96:99], v[60:63]
ds_read_b128 v[152:155], v16 offset:57024
v_mfma_f32_16x16x32_bf16 v[60:63], v[168:171], v[164:167], v[60:63]
ds_read_b64_tr_b16 v[232:233], v22 offset:20480
v_mfma_f32_16x16x32_bf16 v[48:51], v[88:91], v[160:163], v[48:51]
ds_read_b64_tr_b16 v[234:235], v22 offset:20992
s_waitcnt lgkmcnt(4)
v_mfma_f32_16x16x32_bf16 v[48:51], v[168:171], v[184:187], v[48:51]
ds_read_b128 v[236:239], v16 offset:57152
v_mfma_f32_16x16x32_bf16 v[52:55], v[92:95], v[184:187], v[52:55]
ds_read_b128 v[240:243], v16 offset:57280
v_mfma_f32_16x16x32_bf16 v[52:55], v[168:171], v[160:163], v[52:55]
v_mfma_f32_16x16x32_bf16 v[56:59], v[92:95], v[160:163], v[56:59]
ds_read_b128 v[176:179], v16 offset:57408
v_mfma_f32_16x16x32_bf16 v[56:59], v[192:195], v[184:187], v[56:59]
ds_read_b128 v[208:211], v16 offset:58080
v_mfma_f32_16x16x32_bf16 v[60:63], v[180:183], v[184:187], v[60:63]
ds_read_b64_tr_b16 v[188:189], v22 offset:24576
v_mfma_f32_16x16x32_bf16 v[60:63], v[192:195], v[160:163], v[60:63]
ds_read_b64_tr_b16 v[190:191], v22 offset:25088
s_waitcnt lgkmcnt(4)
v_mfma_f32_16x16x32_bf16 v[48:51], v[152:155], v[116:119], v[48:51]
ds_read_b64_tr_b16 v[228:229], v22 offset:28672
v_mfma_f32_16x16x32_bf16 v[48:51], v[236:239], v[232:235], v[48:51]
ds_read_b64_tr_b16 v[230:231], v22 offset:29184
v_mfma_f32_16x16x32_bf16 v[52:55], v[240:243], v[232:235], v[52:55]
v_mfma_f32_16x16x32_bf16 v[52:55], v[236:239], v[116:119], v[52:55]
v_mfma_f32_16x16x32_bf16 v[56:59], v[240:243], v[116:119], v[56:59]
ds_read_b128 v[220:223], v16 offset:58208
s_waitcnt lgkmcnt(2)
v_mfma_f32_16x16x32_bf16 v[56:59], v[176:179], v[232:235], v[56:59]
ds_read_b128 v[200:203], v16 offset:58336
v_mfma_f32_16x16x32_bf16 v[60:63], v[208:211], v[232:235], v[60:63]
s_barrier
ds_read_b64_tr_b16 v[212:213], v22 offset:32768
v_mfma_f32_16x16x32_bf16 v[60:63], v[176:179], v[116:119], v[60:63]
ds_read_b64_tr_b16 v[214:215], v22 offset:33280
v_mfma_f32_16x16x32_bf16 v[48:51], v[240:243], v[188:191], v[48:51]
ds_read_b64_tr_b16 v[172:173], v21 offset:0
s_waitcnt lgkmcnt(4)
v_mfma_f32_16x16x32_bf16 v[48:51], v[176:179], v[228:231], v[48:51]
ds_read_b64_tr_b16 v[174:175], v21 offset:512
v_mfma_f32_16x16x32_bf16 v[52:55], v[208:211], v[228:231], v[52:55]
v_mfma_f32_16x16x32_bf16 v[52:55], v[176:179], v[188:191], v[52:55]
ds_read_b128 v[216:219], v16 offset:58464
v_mfma_f32_16x16x32_bf16 v[56:59], v[208:211], v[188:191], v[56:59]
ds_read_b128 v[204:207], v16 offset:59136
v_mfma_f32_16x16x32_bf16 v[56:59], v[220:223], v[228:231], v[56:59]
ds_read_b64_tr_b16 v[224:225], v21 offset:4096
s_waitcnt lgkmcnt(3)
v_mfma_f32_16x16x32_bf16 v[60:63], v[200:203], v[228:231], v[60:63]
ds_read_b64_tr_b16 v[226:227], v21 offset:4608
v_mfma_f32_16x16x32_bf16 v[60:63], v[220:223], v[188:191], v[60:63]
ds_read_b128 v[252:255], v16 offset:59264
v_mfma_f32_16x16x32_bf16 v[48:51], v[208:211], v[212:215], v[48:51]
ds_read_b64_tr_b16 v[112:113], v21 offset:8192
v_mfma_f32_16x16x32_bf16 v[48:51], v[220:223], v[172:175], v[48:51]
ds_read_b64_tr_b16 v[114:115], v21 offset:8704
v_mfma_f32_16x16x32_bf16 v[52:55], v[200:203], v[172:175], v[52:55]
ds_read_b128 v[248:251], v16 offset:57088
v_mfma_f32_16x16x32_bf16 v[52:55], v[220:223], v[212:215], v[52:55]
ds_read_b64_tr_b16 v[120:121], v21 offset:12288
v_mfma_f32_16x16x32_bf16 v[56:59], v[200:203], v[212:215], v[56:59]
ds_read_b64_tr_b16 v[122:123], v21 offset:12800
s_waitcnt lgkmcnt(4)
v_mfma_f32_16x16x32_bf16 v[56:59], v[216:219], v[172:175], v[56:59]
ds_read_b128 v[244:247], v16 offset:57216
v_mfma_f32_16x16x32_bf16 v[60:63], v[204:207], v[172:175], v[60:63]
ds_read_b128 v[124:127], v16 offset:57344
v_mfma_f32_16x16x32_bf16 v[60:63], v[216:219], v[212:215], v[60:63]
ds_read_b128 v[196:199], v16 offset:57472
v_mfma_f32_16x16x32_bf16 v[48:51], v[200:203], v[224:227], v[48:51]
ds_read_b128 v[136:139], v16 offset:58144
v_mfma_f32_16x16x32_bf16 v[52:55], v[216:219], v[224:227], v[52:55]
s_barrier
ds_read_b64_tr_b16 v[100:101], v21 offset:16384
v_mfma_f32_16x16x32_bf16 v[56:59], v[204:207], v[224:227], v[56:59]
ds_read_b64_tr_b16 v[102:103], v21 offset:16896
v_mfma_f32_16x16x32_bf16 v[60:63], v[252:255], v[224:227], v[60:63]
ds_read_b128 v[140:143], v16 offset:58272
s_waitcnt lgkmcnt(4)
v_mfma_f32_16x16x32_bf16 v[48:51], v[248:251], v[112:115], v[48:51]
ds_read_b64_tr_b16 v[156:157], v21 offset:20480
v_mfma_f32_16x16x32_bf16 v[48:51], v[244:247], v[120:123], v[48:51]
ds_read_b64_tr_b16 v[158:159], v21 offset:20992
v_mfma_f32_16x16x32_bf16 v[52:55], v[124:127], v[120:123], v[52:55]
s_barrier
ds_read_b64_tr_b16 v[96:97], v21 offset:24576
v_mfma_f32_16x16x32_bf16 v[52:55], v[244:247], v[112:115], v[52:55]
ds_read_b64_tr_b16 v[98:99], v21 offset:25088
v_mfma_f32_16x16x32_bf16 v[56:59], v[124:127], v[112:115], v[56:59]
ds_read_b64_tr_b16 v[164:165], v21 offset:28672
v_mfma_f32_16x16x32_bf16 v[56:59], v[196:199], v[120:123], v[56:59]
ds_read_b64_tr_b16 v[166:167], v21 offset:29184
s_waitcnt lgkmcnt(4)
v_mfma_f32_16x16x32_bf16 v[60:63], v[136:139], v[120:123], v[60:63]
ds_read_b64_tr_b16 v[184:185], v21 offset:32768
v_mfma_f32_16x16x32_bf16 v[60:63], v[196:199], v[112:115], v[60:63]
ds_read_b64_tr_b16 v[186:187], v21 offset:33280
v_mfma_f32_16x16x32_bf16 v[48:51], v[124:127], v[100:103], v[48:51]
ds_read_b128 v[160:163], v16 offset:58400
v_mfma_f32_16x16x32_bf16 v[52:55], v[196:199], v[100:103], v[52:55]
ds_read_b128 v[232:235], v16 offset:58528
v_mfma_f32_16x16x32_bf16 v[56:59], v[136:139], v[100:103], v[56:59]
v_mfma_f32_16x16x32_bf16 v[60:63], v[140:143], v[100:103], v[60:63]
ds_read_b128 v[116:119], v16 offset:59200
v_mfma_f32_16x16x32_bf16 v[48:51], v[196:199], v[156:159], v[48:51]
ds_read_b128 v[228:231], v16 offset:59328
s_waitcnt lgkmcnt(3)
v_mfma_f32_16x16x32_bf16 v[48:51], v[136:139], v[96:99], v[48:51]
ds_read_b64_tr_b16 v[188:189], v20 offset:4096
v_mfma_f32_16x16x32_bf16 v[48:51], v[140:143], v[164:167], v[48:51]
ds_read_b64_tr_b16 v[190:191], v20 offset:4608
v_mfma_f32_16x16x32_bf16 v[48:51], v[160:163], v[184:187], v[48:51]
ds_read_b64_tr_b16 v[172:173], v20 offset:8192
s_nop 0
s_waitcnt lgkmcnt(4)
v_mfma_f32_16x16x32_bf16 v[52:55], v[232:235], v[184:187], v[52:55]
ds_read_b64_tr_b16 v[174:175], v20 offset:8704
s_nop 0
v_mfma_f32_16x16x32_bf16 v[52:55], v[160:163], v[164:167], v[52:55]
ds_read_b64_tr_b16 v[212:213], v20 offset:12288
v_cvt_pk_bf16_f32 v72, v48, v49
v_mfma_f32_16x16x32_bf16 v[52:55], v[140:143], v[96:99], v[52:55]
ds_read_b64_tr_b16 v[214:215], v20 offset:12800
v_cvt_pk_bf16_f32 v73, v50, v51
v_mfma_f32_16x16x32_bf16 v[52:55], v[136:139], v[156:159], v[52:55]
ds_read_b64_tr_b16 v[224:225], v20 offset:16384
v_min_u32 v72, -2, v72
v_mfma_f32_16x16x32_bf16 v[56:59], v[140:143], v[156:159], v[56:59]
ds_read_b64_tr_b16 v[226:227], v20 offset:16896
v_min_u32 v73, -2, v73
v_mfma_f32_16x16x32_bf16 v[56:59], v[160:163], v[96:99], v[56:59]
ds_read_b64_tr_b16 v[120:121], v19 offset:0
v_mfma_f32_16x16x32_bf16 v[56:59], v[232:235], v[164:167], v[56:59]
ds_read_b64_tr_b16 v[122:123], v19 offset:512
v_cvt_pk_bf16_f32 v74, v52, v53
v_mfma_f32_16x16x32_bf16 v[56:59], v[116:119], v[184:187], v[56:59]
ds_read_b64_tr_b16 v[112:113], v19 offset:4096
v_cvt_pk_bf16_f32 v75, v54, v55
s_waitcnt lgkmcnt(4)
v_mfma_f32_16x16x32_bf16 v[60:63], v[228:231], v[184:187], v[60:63]
ds_read_b64_tr_b16 v[114:115], v19 offset:4608
v_min_u32 v74, -2, v74
v_mfma_f32_16x16x32_bf16 v[60:63], v[116:119], v[164:167], v[60:63]
ds_read_b64_tr_b16 v[100:101], v19 offset:8192
v_min_u32 v75, -2, v75
v_mfma_f32_16x16x32_bf16 v[60:63], v[232:235], v[96:99], v[60:63]
ds_read_b64_tr_b16 v[102:103], v19 offset:8704
buffer_store_dwordx4 v[72:75], v24, s[60:63], s65 offen offset:0 sc1
v_mfma_f32_16x16x32_bf16 v[60:63], v[160:163], v[156:159], v[60:63]
v_cvt_pk_bf16_f32 v76, v56, v57
v_cvt_pk_bf16_f32 v77, v58, v59
v_mfma_f32_16x16x32_bf16 v[32:35], v[104:107], v[188:191], v[32:35]
v_min_u32 v76, -2, v76
v_min_u32 v77, -2, v77
v_mfma_f32_16x16x32_bf16 v[32:35], v[128:131], v[172:175], v[32:35]
s_nop 0
v_mfma_f32_16x16x32_bf16 v[32:35], v[108:111], v[212:215], v[32:35]
v_cvt_pk_bf16_f32 v78, v60, v61
v_cvt_pk_bf16_f32 v79, v62, v63
s_waitcnt lgkmcnt(0)
v_mfma_f32_16x16x32_bf16 v[32:35], v[132:135], v[224:227], v[32:35]
v_min_u32 v78, -2, v78
v_min_u32 v79, -2, v79
v_mfma_f32_16x16x32_bf16 v[32:35], v[148:151], v[120:123], v[32:35]
buffer_store_dwordx4 v[76:79], v24, s[60:63], s65 offen offset:1024 sc1
v_mfma_f32_16x16x32_bf16 v[32:35], v[144:147], v[112:115], v[32:35]
v_mfma_f32_16x16x32_bf16 v[32:35], v[88:91], v[100:103], v[32:35]
v_mfma_f32_16x16x32_bf16 v[36:39], v[168:171], v[100:103], v[36:39]
v_mfma_f32_16x16x32_bf16 v[36:39], v[88:91], v[112:115], v[36:39]
v_mfma_f32_16x16x32_bf16 v[36:39], v[144:147], v[120:123], v[36:39]
v_mfma_f32_16x16x32_bf16 v[36:39], v[148:151], v[224:227], v[36:39]
v_mfma_f32_16x16x32_bf16 v[36:39], v[132:135], v[212:215], v[36:39]
v_mfma_f32_16x16x32_bf16 v[36:39], v[108:111], v[172:175], v[36:39]
v_mfma_f32_16x16x32_bf16 v[36:39], v[128:131], v[188:191], v[36:39]
v_mfma_f32_16x16x32_bf16 v[40:43], v[108:111], v[188:191], v[40:43]
v_mfma_f32_16x16x32_bf16 v[40:43], v[132:135], v[172:175], v[40:43]
ds_read_b64_tr_b16 v[184:185], v19 offset:12288
v_mfma_f32_16x16x32_bf16 v[40:43], v[148:151], v[212:215], v[40:43]
ds_read_b64_tr_b16 v[186:187], v19 offset:12800
v_mfma_f32_16x16x32_bf16 v[40:43], v[144:147], v[224:227], v[40:43]
ds_read_b64_tr_b16 v[164:165], v19 offset:16384
v_mfma_f32_16x16x32_bf16 v[40:43], v[88:91], v[120:123], v[40:43]
ds_read_b64_tr_b16 v[166:167], v19 offset:16896
v_mfma_f32_16x16x32_bf16 v[40:43], v[168:171], v[112:115], v[40:43]
ds_read_b64_tr_b16 v[96:97], v19 offset:20480
v_mfma_f32_16x16x32_bf16 v[40:43], v[92:95], v[100:103], v[40:43]
ds_read_b64_tr_b16 v[98:99], v19 offset:20992
v_mfma_f32_16x16x32_bf16 v[44:47], v[192:195], v[100:103], v[44:47]
ds_read_b64_tr_b16 v[156:157], v19 offset:24576
v_mfma_f32_16x16x32_bf16 v[44:47], v[92:95], v[112:115], v[44:47]
ds_read_b64_tr_b16 v[158:159], v19 offset:25088
v_mfma_f32_16x16x32_bf16 v[44:47], v[168:171], v[120:123], v[44:47]
ds_read_b64_tr_b16 v[104:105], v19 offset:28672
v_mfma_f32_16x16x32_bf16 v[44:47], v[88:91], v[224:227], v[44:47]
ds_read_b64_tr_b16 v[106:107], v19 offset:29184
v_mfma_f32_16x16x32_bf16 v[44:47], v[144:147], v[212:215], v[44:47]
ds_read_b64_tr_b16 v[128:129], v19 offset:32768
v_mfma_f32_16x16x32_bf16 v[44:47], v[148:151], v[172:175], v[44:47]
ds_read_b64_tr_b16 v[130:131], v19 offset:33280
v_mfma_f32_16x16x32_bf16 v[44:47], v[132:135], v[188:191], v[44:47]
ds_read_b64_tr_b16 v[108:109], v18 offset:0
s_waitcnt lgkmcnt(4)
v_mfma_f32_16x16x32_bf16 v[32:35], v[168:171], v[184:187], v[32:35]
ds_read_b64_tr_b16 v[110:111], v18 offset:512
v_mfma_f32_16x16x32_bf16 v[36:39], v[92:95], v[184:187], v[36:39]
ds_read_b64_tr_b16 v[100:101], v18 offset:4096
v_mfma_f32_16x16x32_bf16 v[40:43], v[192:195], v[184:187], v[40:43]
ds_read_b64_tr_b16 v[102:103], v18 offset:4608
v_mfma_f32_16x16x32_bf16 v[44:47], v[180:183], v[184:187], v[44:47]
v_mfma_f32_16x16x32_bf16 v[32:35], v[152:155], v[164:167], v[32:35]
v_mfma_f32_16x16x32_bf16 v[32:35], v[236:239], v[96:99], v[32:35]
v_mfma_f32_16x16x32_bf16 v[32:35], v[240:243], v[156:159], v[32:35]
s_waitcnt lgkmcnt(0)
v_mfma_f32_16x16x32_bf16 v[32:35], v[176:179], v[104:107], v[32:35]
v_mfma_f32_16x16x32_bf16 v[32:35], v[208:211], v[128:131], v[32:35]
v_mfma_f32_16x16x32_bf16 v[32:35], v[220:223], v[108:111], v[32:35]
v_mfma_f32_16x16x32_bf16 v[32:35], v[200:203], v[100:103], v[32:35]
v_mfma_f32_16x16x32_bf16 v[36:39], v[216:219], v[100:103], v[36:39]
v_mfma_f32_16x16x32_bf16 v[36:39], v[200:203], v[108:111], v[36:39]
v_mfma_f32_16x16x32_bf16 v[36:39], v[220:223], v[128:131], v[36:39]
v_mfma_f32_16x16x32_bf16 v[36:39], v[208:211], v[104:107], v[36:39]
v_mfma_f32_16x16x32_bf16 v[36:39], v[176:179], v[156:159], v[36:39]
v_mfma_f32_16x16x32_bf16 v[36:39], v[240:243], v[96:99], v[36:39]
v_mfma_f32_16x16x32_bf16 v[36:39], v[236:239], v[164:167], v[36:39]
ds_read_b64_tr_b16 v[112:113], v18 offset:8192
s_barrier
ds_read_b32 v6, v27
v_mfma_f32_16x16x32_bf16 v[40:43], v[240:243], v[164:167], v[40:43]
ds_read_b64_tr_b16 v[114:115], v18 offset:8704
buffer_load_dwordx4 v[64:67], v24, s[60:63], s45 offen sc1
v_mfma_f32_16x16x32_bf16 v[40:43], v[176:179], v[96:99], v[40:43]
ds_read_b64_tr_b16 v[120:121], v18 offset:12288
buffer_load_dwordx4 v[68:71], v24, s[60:63], s45 offen offset:1024 sc1
v_mfma_f32_16x16x32_bf16 v[40:43], v[208:211], v[156:159], v[40:43]
ds_read_b64_tr_b16 v[122:123], v18 offset:12800
v_mfma_f32_16x16x32_bf16 v[40:43], v[220:223], v[104:107], v[40:43]
ds_read_b64_tr_b16 v[88:89], v18 offset:16384
v_mfma_f32_16x16x32_bf16 v[40:43], v[200:203], v[128:131], v[40:43]
ds_read_b64_tr_b16 v[90:91], v18 offset:16896
v_mfma_f32_16x16x32_bf16 v[40:43], v[216:219], v[108:111], v[40:43]
ds_read_b64_tr_b16 v[224:225], v18 offset:20480
v_mfma_f32_16x16x32_bf16 v[40:43], v[204:207], v[100:103], v[40:43]
ds_read_b64_tr_b16 v[226:227], v18 offset:20992
v_mfma_f32_16x16x32_bf16 v[44:47], v[252:255], v[100:103], v[44:47]
ds_read_b64_tr_b16 v[144:145], v18 offset:24576
v_mfma_f32_16x16x32_bf16 v[44:47], v[204:207], v[108:111], v[44:47]
ds_read_b64_tr_b16 v[146:147], v18 offset:25088
v_mfma_f32_16x16x32_bf16 v[44:47], v[216:219], v[128:131], v[44:47]
ds_read_b64_tr_b16 v[212:213], v18 offset:28672
v_mfma_f32_16x16x32_bf16 v[44:47], v[200:203], v[104:107], v[44:47]
ds_read_b64_tr_b16 v[214:215], v18 offset:29184
v_mfma_f32_16x16x32_bf16 v[44:47], v[220:223], v[156:159], v[44:47]
ds_read_b64_tr_b16 v[148:149], v18 offset:32768
v_mfma_f32_16x16x32_bf16 v[44:47], v[208:211], v[96:99], v[44:47]
ds_read_b64_tr_b16 v[150:151], v18 offset:33280
v_mfma_f32_16x16x32_bf16 v[44:47], v[176:179], v[164:167], v[44:47]
s_waitcnt lgkmcnt(3)
v_mfma_f32_16x16x32_bf16 v[32:35], v[248:251], v[112:115], v[32:35]
v_mfma_f32_16x16x32_bf16 v[32:35], v[244:247], v[120:123], v[32:35]
v_mfma_f32_16x16x32_bf16 v[32:35], v[124:127], v[88:91], v[32:35]
v_mfma_f32_16x16x32_bf16 v[32:35], v[196:199], v[224:227], v[32:35]
v_mfma_f32_16x16x32_bf16 v[32:35], v[136:139], v[144:147], v[32:35]
s_waitcnt lgkmcnt(0)
v_mfma_f32_16x16x32_bf16 v[32:35], v[140:143], v[212:215], v[32:35]
v_mfma_f32_16x16x32_bf16 v[32:35], v[160:163], v[148:151], v[32:35]
v_mfma_f32_16x16x32_bf16 v[36:39], v[232:235], v[148:151], v[36:39]
v_mfma_f32_16x16x32_bf16 v[36:39], v[160:163], v[212:215], v[36:39]
v_mfma_f32_16x16x32_bf16 v[36:39], v[140:143], v[144:147], v[36:39]
v_mfma_f32_16x16x32_bf16 v[36:39], v[136:139], v[224:227], v[36:39]
v_mfma_f32_16x16x32_bf16 v[36:39], v[196:199], v[88:91], v[36:39]
v_mfma_f32_16x16x32_bf16 v[36:39], v[124:127], v[120:123], v[36:39]
v_mfma_f32_16x16x32_bf16 v[36:39], v[244:247], v[112:115], v[36:39]
v_mfma_f32_16x16x32_bf16 v[40:43], v[124:127], v[112:115], v[40:43]
v_mfma_f32_16x16x32_bf16 v[40:43], v[196:199], v[120:123], v[40:43]
v_mfma_f32_16x16x32_bf16 v[40:43], v[136:139], v[88:91], v[40:43]
v_mfma_f32_16x16x32_bf16 v[40:43], v[140:143], v[224:227], v[40:43]
v_mfma_f32_16x16x32_bf16 v[40:43], v[160:163], v[144:147], v[40:43]
v_mfma_f32_16x16x32_bf16 v[40:43], v[232:235], v[212:215], v[40:43]
v_mfma_f32_16x16x32_bf16 v[40:43], v[116:119], v[148:151], v[40:43]
v_mfma_f32_16x16x32_bf16 v[44:47], v[228:231], v[148:151], v[44:47]
v_readfirstlane_b32 s52, v6
v_mfma_f32_16x16x32_bf16 v[44:47], v[116:119], v[212:215], v[44:47]
s_nop 0
s_cmp_eq_u32 s52, 0
v_mfma_f32_16x16x32_bf16 v[44:47], v[232:235], v[144:147], v[44:47]
s_waitcnt vmcnt(0)
v_max3_u32 v4, v64, v65, v66
v_mfma_f32_16x16x32_bf16 v[44:47], v[160:163], v[224:227], v[44:47]
v_max3_u32 v5, v67, v68, v69
v_max3_u32 v4, v4, v70, v71
v_mfma_f32_16x16x32_bf16 v[44:47], v[140:143], v[88:91], v[44:47]
v_max_u32 v4, v4, v5
v_cmp_eq_u32 vcc, -1, v4
v_mfma_f32_16x16x32_bf16 v[44:47], v[136:139], v[120:123], v[44:47]
s_cbranch_vccnz L_rcvslow
L_rcvok:
s_barrier
v_mfma_f32_16x16x32_bf16 v[44:47], v[196:199], v[112:115], v[44:47]
v_mfma_f32_16x16x32_bf16 v[32:35], v[82:85], v[64:67], v[32:35]
v_mfma_f32_16x16x32_bf16 v[36:39], v[80:83], v[64:67], v[36:39]
v_mfma_f32_16x16x32_bf16 v[40:43], v[82:85], v[68:71], v[40:43]
v_mfma_f32_16x16x32_bf16 v[44:47], v[80:83], v[68:71], v[44:47]
s_nop 4
v_pk_mul_f32 v[8:9], v[34:35], s[18:19]
v_pk_mul_f32 v[30:31], v[32:33], v[32:33]
v_pk_add_f32 v[28:29], v[32:33], v[8:9]
v_pk_fma_f32 v[30:31], v[8:9], v[8:9], v[30:31]
v_pk_mul_f32 v[8:9], v[38:39], v[38:39]
v_pk_add_f32 v[28:29], v[28:29], v[36:37]
v_pk_fma_f32 v[30:31], v[36:37], v[36:37], v[30:31]
v_pk_add_f32 v[4:5], v[38:39], v[42:43]
v_pk_fma_f32 v[8:9], v[42:43], v[42:43], v[8:9]
v_pk_add_f32 v[28:29], v[28:29], v[40:41]
v_pk_fma_f32 v[30:31], v[40:41], v[40:41], v[30:31]
v_pk_add_f32 v[4:5], v[4:5], v[46:47]
v_pk_fma_f32 v[8:9], v[46:47], v[46:47], v[8:9]
v_pk_add_f32 v[28:29], v[28:29], v[44:45]
v_pk_fma_f32 v[30:31], v[44:45], v[44:45], v[30:31]
v_pk_fma_f32 v[28:29], v[4:5], s[18:19], v[28:29] op_sel:[0,1,0]
v_pk_fma_f32 v[30:31], v[8:9], s[18:19], v[30:31] op_sel:[0,1,0]
v_add_f32 v28, v28, v29
v_add_f32 v30, v30, v31
s_nop 1
v_permlane32_swap_b32 v28, v30
v_add_f32 v28, v28, v30
v_mov_b32 v29, v28
s_cbranch_scc1 L_pubfar
s_nop 0
v_permlane16_swap_b32 v28, v29
v_add_f32_e64 v28, v28, v29
v_min_u32 v28, -2, v28
buffer_store_dword v28, v25, s[60:63], s46 offen
L_pubok:
ds_write2_b32 v26, v32, v36 offset0:0 offset1:36
ds_write2_b32 v26, v40, v44 offset0:72 offset1:108
ds_write2_b32 v26, v33, v37 offset0:144 offset1:180
ds_write2_b32 v26, v41, v45 offset0:216 offset1:252
ds_write2_b32 v17, v34, v38 offset0:0 offset1:36
ds_write2_b32 v17, v42, v46 offset0:72 offset1:108
ds_write2_b32 v17, v35, v39 offset0:144 offset1:180
ds_write2_b32 v17, v43, v47 offset0:216 offset1:252
s_waitcnt lgkmcnt(0)
L_final:
s_barrier
ds_read_b128 v[48:51], v11
ds_read_b128 v[52:55], v11 offset:1152
s_barrier
buffer_store_dword v28, v25, s[60:63], s46 offen sc1
L_final2:
s_waitcnt lgkmcnt(0)
s_barrier
ds_read_b128 v[32:35], v12 offset:0
ds_read_b128 v[40:43], v12 offset:128
v_lshl_add_u32 v13, v15, 3, v13
v_mov_b32 v14, 0x3eeff558
v_mov_b32_e64 v15, v14
s_waitcnt lgkmcnt(0)
v_pk_fma_f32 v[48:49], v[48:49], v[32:33], v[40:41]
v_pk_fma_f32 v[50:51], v[50:51], v[34:35], v[42:43]
v_pk_fma_f32 v[56:57], v[48:49], v[48:49], s[28:29] op_sel_hi:[1,1,0]
v_pk_fma_f32 v[58:59], v[50:51], v[50:51], s[28:29] op_sel_hi:[1,1,0]
v_pk_fma_f32 v[56:57], v[56:57], v[48:49], s[28:29] op_sel:[0,0,1] neg_lo:[1,0,0] neg_hi:[1,0,0]
v_pk_fma_f32 v[58:59], v[58:59], v[50:51], s[28:29] op_sel:[0,0,1] neg_lo:[1,0,0] neg_hi:[1,0,0]
v_exp_f32 v56, v56
v_exp_f32 v57, v57
v_exp_f32 v58, v58
v_exp_f32 v59, v59
v_pk_add_f32 v[56:57], v[56:57], v[14:15]
v_pk_add_f32 v[58:59], v[58:59], v[14:15]
v_rcp_f32 v56, v56
v_rcp_f32 v57, v57
v_rcp_f32 v58, v58
v_rcp_f32 v59, v59
v_pk_mul_f32 v[56:57], v[56:57], v[48:49]
v_pk_mul_f32 v[58:59], v[58:59], v[50:51]
v_cvt_pk_bf16_f32 v36, v56, v57
v_cvt_pk_bf16_f32 v37, v58, v59
buffer_store_dwordx2 v[36:37], v13, s[56:59], s64 offen sc1
v_pk_fma_f32 v[52:53], v[52:53], v[32:33], v[40:41]
v_pk_fma_f32 v[54:55], v[54:55], v[34:35], v[42:43]
v_pk_fma_f32 v[60:61], v[52:53], v[52:53], s[28:29] op_sel_hi:[1,1,0]
v_pk_fma_f32 v[62:63], v[54:55], v[54:55], s[28:29] op_sel_hi:[1,1,0]
v_pk_fma_f32 v[60:61], v[60:61], v[52:53], s[28:29] op_sel:[0,0,1] neg_lo:[1,0,0] neg_hi:[1,0,0]
v_pk_fma_f32 v[62:63], v[62:63], v[54:55], s[28:29] op_sel:[0,0,1] neg_lo:[1,0,0] neg_hi:[1,0,0]
v_exp_f32 v60, v60
v_exp_f32 v61, v61
v_exp_f32 v62, v62
v_exp_f32 v63, v63
v_pk_add_f32 v[60:61], v[60:61], v[14:15]
v_pk_add_f32 v[62:63], v[62:63], v[14:15]
v_rcp_f32 v60, v60
v_rcp_f32 v61, v61
v_rcp_f32 v62, v62
v_rcp_f32 v63, v63
v_pk_mul_f32 v[60:61], v[60:61], v[52:53]
v_pk_mul_f32 v[62:63], v[62:63], v[54:55]
v_cvt_pk_bf16_f32 v38, v60, v61
v_cvt_pk_bf16_f32 v39, v62, v63
buffer_store_dwordx2 v[38:39], v13, s[56:59], s53 offen sc1
L_fin:
s_endpgm
L_pad2:
s_branch L_compute
L_pollchk:
buffer_load_dwordx4 v[80:83], v24, s[60:63], s43 offen offset:0 sc1
buffer_load_dwordx4 v[84:87], v24, s[60:63], s43 offen offset:1024 sc1
buffer_load_dwordx4 v[88:91], v24, s[60:63], s43 offen offset:2048 sc1
buffer_load_dwordx4 v[92:95], v24, s[60:63], s43 offen offset:3072 sc1
s_waitcnt vmcnt(0)
v_pk_add_f32 v[56:57], v[80:81], v[84:85]
v_pk_add_f32 v[58:59], v[82:83], v[86:87]
v_pk_add_f32 v[56:57], v[56:57], v[88:89]
v_pk_add_f32 v[58:59], v[58:59], v[90:91]
v_pk_add_f32 v[56:57], v[56:57], v[92:93]
v_pk_add_f32 v[58:59], v[58:59], v[94:95]
s_nop 1
v_permlane32_swap_b32 v56, v58
v_permlane32_swap_b32 v57, v59
v_pk_add_f32 v[28:29], v[56:57], v[58:59]
v_cmp_u_f32 vcc, v28, v29
v_max3_u32 v4, v80, v81, v82
v_max3_u32 v5, v83, v84, v85
v_max3_u32 v4, v4, v86, v87
v_max3_u32 v5, v5, v88, v89
v_max3_u32 v4, v4, v90, v91
v_max3_u32 v5, v5, v92, v93
v_max3_u32 v4, v4, v94, v95
v_max_u32 v4, v4, v5
v_cmp_eq_u32 vcc, -1, v4
s_cbranch_vccz L_pollok
s_cmp_eq_u32 s67, 0
s_cbranch_scc1 L_pollok
s_branch L_poll
L_rcvslow:
s_mov_b32 s67, 0x40000
L_rcvloop:
buffer_load_dwordx4 v[64:67], v24, s[60:63], s45 offen sc1
buffer_load_dwordx4 v[68:71], v24, s[60:63], s45 offen offset:1024 sc1
s_sub_u32 s67, s67, 1
s_waitcnt vmcnt(0)
s_cbranch_scc1 L_rcvend
v_max3_u32 v4, v64, v65, v66
v_max3_u32 v5, v67, v68, v69
v_max3_u32 v4, v4, v70, v71
v_max_u32 v4, v4, v5
v_cmp_eq_u32 vcc, -1, v4
s_cbranch_vccnz L_rcvloop
L_rcvend:
s_cmp_eq_u32 s52, 0
s_branch L_rcvok
L_w23:
s_barrier
ds_read_b128 v[48:51], v11
ds_read_b128 v[52:55], v11 offset:1152
s_barrier
s_branch L_final3
L_pubfar:
s_nop 0
v_permlane16_swap_b32 v28, v29
v_add_f32 v28, v28, v29
v_min_u32 v28, -2, v28
buffer_store_dword v28, v25, s[60:63], s46 offen sc1
s_branch L_pubok
L_service:
s_cbranch_execz L_compute
buffer_load_dword v19, v25, s[60:63], s46 offen sc1
s_mul_i32 s41, s34, 1020416
s_add_u32 s56, s12, s41
s_addc_u32 s57, s13, 0
s_mov_b32 s58, 1020416
s_mov_b32 s59, 0x20000
v_lshrrev_b32 v14, 3, v0
v_and_b32 v15, 7, v0
v_mul_u32_u24 v11, 144, v14
v_lshl_add_u32 v11, v15, 4, v11
s_mul_i32 s41, s35, 2304
s_add_u32 s41, s41, 112896
v_add_u32 v11, s41, v11
v_lshlrev_b32 v12, 4, v15
v_add_u32 v12, 131328, v12
v_lshlrev_b32 v13, 9, v14
s_lshl_b32 s64, s32, 16
s_lshl_b32 s41, s35, 13
s_add_u32 s64, s64, s41
s_add_u32 s64, s64, s55
s_add_u32 s53, s64, 0x1000
s_mov_b32 s28, 0x409d30fc
s_mov_b32 s29, 0xbf8bf336
v_mov_b32 v8, 0x3a038849
v_bfe_i32 v9, v0, 4, 1
v_and_b32 v9, 0x36a7c5ac, v9
s_lshl_b32 s41, s38, 6
s_add_u32 s41, s41, 131328
v_lshl_add_u32 v22, v16, 2, s41
s_cmp_lg_u32 s35, 3
s_cbranch_scc1 L_flagdone
s_mov_b32 s67, 0x40000
s_waitcnt lgkmcnt(0)
s_mov_b64 s[50:51], s[4:5]
L_flag:
s_and_b32 s40, s50, s51
s_bitcmp1_b32 s40, 4
s_cbranch_scc1 L_flagok
s_mov_b64 s[50:51], 0
s_atomic_add_x2 s[50:51], s[16:17], s47 glc
s_sub_u32 s67, s67, 1
s_cmp_lg_u32 s67, 0
s_waitcnt lgkmcnt(0)
s_cbranch_scc1 L_flag
L_flagok:
s_cmp_eq_u32 s30, 0
s_cselect_b32 s40, s50, s51
s_or_b32 s41, s18, s19
s_lshl_b32 s41, s41, 4
s_cmp_eq_u32 s40, s41
s_cselect_b32 s40, 1, 0
v_mov_b32 v27, s40
v_mov_b32 v26, 162048
ds_write_b32 v26, v27
s_waitcnt lgkmcnt(0)
L_flagdone:
v_lshlrev_b32 v20, 16, v20
v_lshlrev_b32 v21, 16, v21
v_mul_f32 v20, 0x3eeff558, v20
v_mul_f32 v21, 0x3eeff558, v21
s_barrier
s_cmp_ge_u32 s35, 2
s_barrier
s_cbranch_scc1 L_w23
buffer_load_dwordx4 v[80:83], v24, s[60:63], s43 offen offset:0 sc1
buffer_load_dwordx4 v[84:87], v24, s[60:63], s43 offen offset:1024 sc1
buffer_load_dwordx4 v[88:91], v24, s[60:63], s43 offen offset:2048 sc1
buffer_load_dwordx4 v[92:95], v24, s[60:63], s43 offen offset:3072 sc1
s_mov_b32 s67, 0xfffff
s_nop 0
s_waitcnt vmcnt(0)
v_cmp_eq_u32 s[20:21], -1, v83
v_cmp_eq_u32 s[22:23], -1, v87
v_cmp_eq_u32 s[24:25], -1, v91
v_cmp_eq_u32 s[26:27], -1, v95
s_or_b64 exec, s[20:21], 1
buffer_load_dwordx4 v[80:83], v24, s[60:63], s43 offen offset:0 sc1
s_or_b64 exec, s[22:23], 1
buffer_load_dwordx4 v[84:87], v24, s[60:63], s43 offen offset:1024 sc1
s_or_b64 exec, s[24:25], 1
buffer_load_dwordx4 v[88:91], v24, s[60:63], s43 offen offset:2048 sc1
s_or_b64 exec, s[26:27], 1
buffer_load_dwordx4 v[92:95], v24, s[60:63], s43 offen offset:3072 sc1
s_mov_b64 exec, -1
s_barrier
ds_read_b128 v[48:51], v11
ds_read_b128 v[52:55], v11 offset:1152
L_poll:
s_or_b64 exec, s[20:21], 1
buffer_load_dwordx4 v[80:83], v24, s[60:63], s43 offen offset:0 sc1
s_or_b64 exec, s[22:23], 1
buffer_load_dwordx4 v[84:87], v24, s[60:63], s43 offen offset:1024 sc1
s_or_b64 exec, s[24:25], 1
buffer_load_dwordx4 v[88:91], v24, s[60:63], s43 offen offset:2048 sc1
s_or_b64 exec, s[26:27], 1
buffer_load_dwordx4 v[92:95], v24, s[60:63], s43 offen offset:3072 sc1
s_mov_b64 exec, -1
s_sub_u32 s67, s67, 1
s_and_b32 s40, s67, 15
s_cbranch_scc0 L_pollchk
s_nop 0
s_waitcnt vmcnt(4)
v_pk_add_f32 v[56:57], v[80:81], v[84:85]
v_pk_add_f32 v[58:59], v[82:83], v[86:87]
v_pk_add_f32 v[56:57], v[56:57], v[88:89]
v_pk_add_f32 v[58:59], v[58:59], v[90:91]
v_pk_add_f32 v[56:57], v[56:57], v[92:93]
v_pk_add_f32 v[58:59], v[58:59], v[94:95]
v_cmp_eq_u32 s[20:21], -1, v83
v_cmp_eq_u32 s[22:23], -1, v87
v_cmp_eq_u32 s[24:25], -1, v91
v_cmp_eq_u32 s[26:27], -1, v95
v_permlane32_swap_b32 v56, v58
v_permlane32_swap_b32 v57, v59
v_pk_add_f32 v[28:29], v[56:57], v[58:59]
v_cmp_u_f32 vcc, v28, v29
s_cbranch_vccnz L_poll
L_pollok:
s_barrier
v_permlane16_swap_b32 v28, v29
v_add_f32 v28, v28, v29
v_fma_f32 v28, v28, v8, v9
s_nop 1
v_add_f32_dpp v29, v28, v28 row_ror:8 row_mask:0xf bank_mask:0xf
v_add_f32_dpp v28, v28, v28 row_ror:8 row_mask:0xf bank_mask:0xf
s_nop 1
v_permlane16_swap_b32 v28, v29
v_fma_f32 v29, -v28, v28, v29
v_max_f32 v29, 0x3727c5ac, v29
v_rsq_f32 v29, v29
s_nop 0
v_mul_f32 v30, v29, v20
v_fma_f32 v31, -v28, v30, v21
ds_write2_b32 v22, v30, v31 offset0:0 offset1:32
L_final3:
s_waitcnt lgkmcnt(0)
s_barrier
ds_read_b128 v[32:35], v12 offset:0
ds_read_b128 v[40:43], v12 offset:128
v_lshl_add_u32 v13, v15, 3, v13
v_mov_b32 v14, 0x3eeff558
v_mov_b32_e64 v15, v14
s_waitcnt lgkmcnt(0)
v_pk_fma_f32 v[48:49], v[48:49], v[32:33], v[40:41]
v_pk_fma_f32 v[50:51], v[50:51], v[34:35], v[42:43]
v_pk_fma_f32 v[56:57], v[48:49], v[48:49], s[28:29] op_sel_hi:[1,1,0]
v_pk_fma_f32 v[58:59], v[50:51], v[50:51], s[28:29] op_sel_hi:[1,1,0]
v_pk_fma_f32 v[56:57], v[56:57], v[48:49], s[28:29] op_sel:[0,0,1] neg_lo:[1,0,0] neg_hi:[1,0,0]
v_pk_fma_f32 v[58:59], v[58:59], v[50:51], s[28:29] op_sel:[0,0,1] neg_lo:[1,0,0] neg_hi:[1,0,0]
v_exp_f32 v56, v56
v_exp_f32 v57, v57
v_exp_f32 v58, v58
v_exp_f32 v59, v59
v_pk_add_f32 v[56:57], v[56:57], v[14:15]
v_pk_add_f32 v[58:59], v[58:59], v[14:15]
v_rcp_f32 v56, v56
v_rcp_f32 v57, v57
v_rcp_f32 v58, v58
v_rcp_f32 v59, v59
v_pk_mul_f32 v[56:57], v[56:57], v[48:49]
v_pk_mul_f32 v[58:59], v[58:59], v[50:51]
v_cvt_pk_bf16_f32 v36, v56, v57
v_cvt_pk_bf16_f32 v37, v58, v59
buffer_store_dwordx2 v[36:37], v13, s[56:59], s64 offen sc1
v_pk_fma_f32 v[52:53], v[52:53], v[32:33], v[40:41]
v_pk_fma_f32 v[54:55], v[54:55], v[34:35], v[42:43]
v_pk_fma_f32 v[60:61], v[52:53], v[52:53], s[28:29] op_sel_hi:[1,1,0]
v_pk_fma_f32 v[62:63], v[54:55], v[54:55], s[28:29] op_sel_hi:[1,1,0]
v_pk_fma_f32 v[60:61], v[60:61], v[52:53], s[28:29] op_sel:[0,0,1] neg_lo:[1,0,0] neg_hi:[1,0,0]
v_pk_fma_f32 v[62:63], v[62:63], v[54:55], s[28:29] op_sel:[0,0,1] neg_lo:[1,0,0] neg_hi:[1,0,0]
v_exp_f32 v60, v60
v_exp_f32 v61, v61
v_exp_f32 v62, v62
v_exp_f32 v63, v63
v_pk_add_f32 v[60:61], v[60:61], v[14:15]
v_pk_add_f32 v[62:63], v[62:63], v[14:15]
v_rcp_f32 v60, v60
v_rcp_f32 v61, v61
v_rcp_f32 v62, v62
v_rcp_f32 v63, v63
v_pk_mul_f32 v[60:61], v[60:61], v[52:53]
v_pk_mul_f32 v[62:63], v[62:63], v[54:55]
v_cvt_pk_bf16_f32 v38, v60, v61
v_cvt_pk_bf16_f32 v39, v62, v63
buffer_store_dwordx2 v[38:39], v13, s[56:59], s53 offen sc1
s_endpgm
.section .rodata,"a"
.p2align 6
.amdhsa_kernel standalone__self_sup_conv_stem_wavlm__speech_kernel
  .amdhsa_next_free_vgpr 256
  .amdhsa_next_free_sgpr 102
  .amdhsa_accum_offset 256
  .amdhsa_group_segment_fixed_size 0
  .amdhsa_kernarg_size 56
  .amdhsa_user_sgpr_count 2
  .amdhsa_user_sgpr_kernarg_segment_ptr 1
  .amdhsa_system_sgpr_workgroup_id_x 1
  .amdhsa_float_denorm_mode_32 3
.end_amdhsa_kernel
```
